```python
import torch

def _softmax(x, axis=-1):
    return torch.softmax(x, dim=axis)
def _gelu(x):
    return torch.nn.functional.gelu(x, approximate="tanh")
def _silu(x):
    return torch.nn.functional.silu(x)
def _sigmoid(x):
    return torch.sigmoid(x)
def _layernorm(x, axis=-1, eps=1e-5):
    m = x.mean(dim=axis, keepdim=True)
    v = x.var(dim=axis, keepdim=True, unbiased=False)
    return (x - m) / torch.sqrt(v + eps)
def _scatter_add(tgt, idx, src, axis=0):
    return tgt.clone().index_add_(axis, idx, src)
def _segment_sum(src, seg, n):
    out = torch.zeros((n,) + src.shape[1:], dtype=src.dtype)
    return out.index_add_(0, seg, src)
def _pad(x, pw):
    flat = tuple(v for pair in reversed(pw) for v in pair)
    return torch.nn.functional.pad(x, flat)

kernel_name = 'standalone__mha_block_cached__near_ridge'

def setup_inputs():

    _w = (lambda a: (lambda t: t.to(torch.bfloat16) if t.is_floating_point() else t)(torch.as_tensor(a)))
    B, Sq, D = 32, 64, 576
    H, Sk, Dh = 32, 512, 128
    return {
        "x": _w((lambda *s: torch.randn(*s, dtype=torch.bfloat16) * 0.8)(B, Sq, D)),
        "k_cache": _w((lambda *s: torch.randn(*s, dtype=torch.bfloat16) * 0.8)(B, H, Sk, Dh)),
        "v_cache": _w((lambda *s: torch.randn(*s, dtype=torch.bfloat16) * 0.05)(B, H, Sk, Dh)),
        "wq": _w((lambda *s: torch.randn(*s, dtype=torch.bfloat16) * 0.8)(D, H * Dh) * (D ** -0.5)),
        "wo": _w((lambda *s: torch.randn(*s, dtype=torch.bfloat16) * 0.05)(H * Dh, D) * ((H * Dh) ** -0.5)),
    }

def reference(x, k_cache, v_cache, wq, wo):
    B, Sq, D = x.shape
    H, Dh = 32, 128
    q = (lambda x, *d: x.permute(*d))((x @ wq).reshape(B, Sq, H, Dh), 0, 2, 1, 3)
    scores = torch.einsum("bhqd,bhkd->bhqk", q, k_cache) * (Dh ** -0.5)
    p = _softmax(scores, axis=-1)
    o = torch.einsum("bhqk,bhkd->bhqd", p, v_cache)
    return (lambda x, *d: x.permute(*d))(o, 0, 2, 1, 3).reshape(B, Sq, H * Dh) @ wo
```

```asm
; @launch grid=(256,1,1) block=(256,1,1) lds=163840
.amdgcn_target "amdgcn-amd-amdhsa--gfx950"
.text
.globl standalone__mha_block_cached__near_ridge_kernel
.p2align 8
.type standalone__mha_block_cached__near_ridge_kernel,@function
standalone__mha_block_cached__near_ridge_kernel:
s_cmp_ge_u32 s2, 256
s_cbranch_scc1 L_done
s_load_dwordx2 s[20:21], s[0:1], 0
s_load_dwordx2 s[12:13], s[0:1], 24
s_load_dwordx2 s[4:5], s[0:1], 8
s_load_dwordx2 s[8:9], s[0:1], 16
s_load_dwordx2 s[16:17], s[0:1], 32
s_load_dwordx2 s[28:29], s[0:1], 40
s_load_dwordx2 s[32:33], s[0:1], 48
s_load_dwordx2 s[24:25], s[0:1], 56
s_getpc_b64 s[56:57]
L_pc:
v_lshlrev_b32 v113, 7, v0
v_mov_b32 v115, s57
v_add_co_u32 v114, vcc, s56, v113
s_nop 1
v_addc_co_u32 v115, vcc, 0, v115, vcc
v_cmp_gt_u32 vcc, L_done-L_pc, v113
s_nop 3
s_and_saveexec_b64 s[54:55], vcc
s_cbranch_execz L_cpf_skip
global_load_dword v116, v[114:115], off
L_cpf_skip:
s_mov_b64 exec, s[54:55]
v_and_b32 v100, 63, v0
v_lshrrev_b32 v107, 6, v0
s_nop 0
v_readfirstlane_b32 s36, v107
v_and_b32 v101, 15, v100
v_lshrrev_b32 v102, 4, v100
s_nop 1
s_lshl_b32 s37, s36, 12
s_and_b32 s39, s2, 7
s_lshr_b32 s38, s2, 3
v_lshlrev_b32 v240, 4, v100
s_and_b32 s49, s36, 1
s_lshl_b32 s49, s49, 3
v_and_b32 v107, 1, v102
v_lshrrev_b32 v108, 1, v102
v_lshl_or_b32 v107, v108, 2, v107
v_or_b32 v107, s49, v107
v_xor_b32 v107, v107, v101
v_lshlrev_b32 v107, 4, v107
v_lshl_add_u32 v107, v102, 13, v107
s_lshl_b32 s50, s36, 17
v_add_u32 v210, s50, v107
v_add_u32 v211, 31744, v210
v_add_u32 v212, 63488, v210
v_add_u32 v213, 95232, v210
s_lshl_b32 s42, s39, 10
s_lshl_b32 s58, s38, 2
s_add_u32 s58, s58, s36
s_lshl_b32 s58, s58, 1
s_cmp_ge_u32 s58, 144
s_cselect_b32 s59, 144, 0
s_sub_u32 s58, s58, s59
s_lshl_b32 s58, s58, 15
s_add_u32 s58, s58, s42
v_lshrrev_b32 v107, 4, v100
v_lshlrev_b32 v107, 13, v107
v_and_b32 v108, 15, v100
v_lshl_add_u32 v113, v108, 4, v107
s_add_u32 m0, s37, 147456
s_lshl_b32 s53, s38, 6
s_lshl_b32 s56, s36, 4
s_add_u32 s53, s53, s56
s_mul_i32 s53, s53, 1152
v_mul_u32_u24 v107, 1152, v101
v_lshl_add_u32 v112, v102, 5, v107
s_mov_b32 s22, 0x240000
s_mov_b32 s23, 0x20000
s_mov_b32 s14, 0x480000
s_mov_b32 s15, 0x20000
s_waitcnt lgkmcnt(0)
buffer_load_dwordx4 v113, s[12:15], s58 offen lds
s_add_u32 s58, s58, 32768
buffer_load_dwordx4 v113, s[12:15], s58 offen lds
buffer_load_dwordx4 a[144:147], v112, s[20:23], s53 offen offset:0
buffer_load_dwordx4 a[148:151], v112, s[20:23], s53 offen offset:16
buffer_load_dwordx4 a[152:155], v112, s[20:23], s53 offen offset:128
buffer_load_dwordx4 a[156:159], v112, s[20:23], s53 offen offset:144
buffer_load_dwordx4 a[160:163], v112, s[20:23], s53 offen offset:256
buffer_load_dwordx4 a[164:167], v112, s[20:23], s53 offen offset:272
buffer_load_dwordx4 a[168:171], v112, s[20:23], s53 offen offset:384
buffer_load_dwordx4 a[172:175], v112, s[20:23], s53 offen offset:400
buffer_load_dwordx4 a[176:179], v112, s[20:23], s53 offen offset:512
buffer_load_dwordx4 a[180:183], v112, s[20:23], s53 offen offset:528
buffer_load_dwordx4 a[184:187], v112, s[20:23], s53 offen offset:640
buffer_load_dwordx4 a[188:191], v112, s[20:23], s53 offen offset:656
buffer_load_dwordx4 a[192:195], v112, s[20:23], s53 offen offset:768
buffer_load_dwordx4 a[196:199], v112, s[20:23], s53 offen offset:784
buffer_load_dwordx4 a[200:203], v112, s[20:23], s53 offen offset:896
buffer_load_dwordx4 a[204:207], v112, s[20:23], s53 offen offset:912
buffer_load_dwordx4 a[208:211], v112, s[20:23], s53 offen offset:1024
buffer_load_dwordx4 a[212:215], v112, s[20:23], s53 offen offset:1040
s_add_u32 m0, s37, 114688
s_add_u32 s48, s42, 0
buffer_load_dwordx4 v210, s[12:15], s48 offen lds
buffer_load_dwordx4 v211, s[12:15], s48 offen offset:1024 lds
buffer_load_dwordx4 v212, s[12:15], s48 offen offset:2048 lds
buffer_load_dwordx4 v213, s[12:15], s48 offen offset:3072 lds
s_add_u32 m0, s37, 131072
s_add_u32 s49, s42, 524288
buffer_load_dwordx4 v210, s[12:15], s49 offen lds
buffer_load_dwordx4 v211, s[12:15], s49 offen offset:1024 lds
buffer_load_dwordx4 v212, s[12:15], s49 offen offset:2048 lds
buffer_load_dwordx4 v213, s[12:15], s49 offen offset:3072 lds
s_add_u32 m0, s37, 0
s_add_u32 s48, s42, 1048576
buffer_load_dwordx4 v210, s[12:15], s48 offen lds
buffer_load_dwordx4 v211, s[12:15], s48 offen offset:1024 lds
buffer_load_dwordx4 v212, s[12:15], s48 offen offset:2048 lds
buffer_load_dwordx4 v213, s[12:15], s48 offen offset:3072 lds
s_add_u32 m0, s37, 16384
s_add_u32 s49, s42, 1572864
buffer_load_dwordx4 v210, s[12:15], s49 offen lds
buffer_load_dwordx4 v211, s[12:15], s49 offen offset:1024 lds
buffer_load_dwordx4 v212, s[12:15], s49 offen offset:2048 lds
buffer_load_dwordx4 v213, s[12:15], s49 offen offset:3072 lds
s_add_u32 m0, s37, 32768
s_add_u32 s48, s42, 2097152
buffer_load_dwordx4 v210, s[12:15], s48 offen lds
buffer_load_dwordx4 v211, s[12:15], s48 offen offset:1024 lds
buffer_load_dwordx4 v212, s[12:15], s48 offen offset:2048 lds
buffer_load_dwordx4 v213, s[12:15], s48 offen offset:3072 lds
s_and_b32 s49, s36, 1
s_lshl_b32 s49, s49, 3
v_lshrrev_b32 v103, 2, v100
v_and_b32 v103, 3, v103
v_and_b32 v104, 3, v100
s_lshl_b32 s48, s36, 2
v_add_u32 v107, s48, v102
v_xor_b32 v107, v107, v101
v_lshlrev_b32 v107, 4, v107
v_lshl_add_u32 v107, v102, 8, v107
v_add_u32 v208, s37, v107
v_lshlrev_b32 v107, 1, v102
v_or_b32 v107, s49, v107
v_xor_b32 v107, v107, v101
v_lshlrev_b32 v107, 4, v107
v_lshl_add_u32 v107, v102, 8, v107
v_add_u32 v209, s37, v107
v_lshrrev_b32 v107, 3, v100
v_and_b32 v108, 6, v107
v_and_b32 v106, 7, v100
v_xor_b32 v108, v108, v106
v_lshlrev_b32 v108, 4, v108
v_mul_u32_u24 v107, 1152, v107
v_add_u32 v107, v107, v108
s_mul_i32 s50, s36, 36864
v_add_u32 v214, s50, v107
v_add_u32 v215, 8192, v214
v_add_u32 v216, 16384, v214
v_add_u32 v217, 24576, v214
v_lshrrev_b32 v107, 2, v101
v_lshlrev_b32 v107, 12, v107
v_and_b32 v108, 3, v101
v_lshl_add_u32 v107, v108, 8, v107
v_xor_b32 v108, v102, v101
v_lshl_add_u32 v226, v108, 4, v107
v_lshlrev_b32 v109, 4, v102
v_add_u32 v109, v109, v103
v_lshlrev_b32 v109, 8, v109
v_and_b32 v110, 1, v102
v_lshlrev_b32 v110, 3, v110
v_and_b32 v111, 1, v104
v_lshlrev_b32 v111, 3, v111
v_lshl_or_b32 v107, v103, 1, v110
v_lshrrev_b32 v108, 1, v104
v_xor_b32 v107, v107, v108
v_lshl_add_u32 v107, v107, 4, v111
v_add_u32 v227, v109, v107
v_and_b32 v107, 1, v103
v_lshrrev_b32 v108, 1, v103
v_lshl_or_b32 v107, v108, 2, v107
v_or_b32 v107, v107, v110
v_xor_b32 v107, v107, v104
v_lshl_add_u32 v107, v107, 4, v111
v_add_u32 v228, v109, v107
v_lshrrev_b32 v107, 1, v103
v_lshlrev_b32 v107, 1, v107
v_lshrrev_b32 v108, 1, v110
v_or_b32 v107, v107, v108
v_lshrrev_b32 v108, 1, v104
s_lshl_b32 s50, s36, 1
v_add_u32 v108, s50, v108
v_xor_b32 v107, v107, v108
v_lshl_add_u32 v107, v107, 4, v111
v_lshlrev_b32 v108, 2, v102
v_add_u32 v108, v108, v103
v_lshl_add_u32 v229, v108, 7, v107
v_and_b32 v107, 1, v102
v_cmp_eq_u32 s[46:47], 1, v107
s_lshl_b32 s50, s36, 10
v_add_u32 v241, s50, v240
v_mul_u32_u24 v243, 1152, v101
v_lshl_add_u32 v243, v102, 3, v243
s_lshl_b32 s40, s38, 5
s_lshl_b32 s50, s39, 2
s_add_u32 s40, s40, s50
s_lshl_b32 s40, s40, 17
s_mov_b32 s41, s40
s_mul_i32 s43, s39, 589824
s_mov_b32 s45, 0x3e0293ee
s_and_b32 s86, s38, 1
s_lshl_b32 s52, s38, 3
s_add_u32 s52, s52, s39
s_mul_i32 s52, s52, 73728
v_mov_b32 v232, 0
v_mov_b32 v233, 0
v_mov_b32 v234, 0
v_mov_b32 v235, 0
v_mov_b32 v236, 0x3f803f80
s_nop 0
v_mfma_f32_32x32x16_bf16 a[0:15], v[232:235], v[232:235], 0
v_mfma_f32_32x32x16_bf16 a[16:31], v[232:235], v[232:235], 0
v_mfma_f32_32x32x16_bf16 a[32:47], v[232:235], v[232:235], 0
v_mfma_f32_32x32x16_bf16 a[48:63], v[232:235], v[232:235], 0
v_mfma_f32_32x32x16_bf16 a[64:79], v[232:235], v[232:235], 0
v_mfma_f32_32x32x16_bf16 a[80:95], v[232:235], v[232:235], 0
v_mfma_f32_32x32x16_bf16 a[96:111], v[232:235], v[232:235], 0
v_mfma_f32_32x32x16_bf16 a[112:127], v[232:235], v[232:235], 0
v_mfma_f32_32x32x16_bf16 a[128:143], v[232:235], v[232:235], 0
v_accvgpr_write_b32 a252, v236
v_accvgpr_write_b32 a253, v236
v_accvgpr_write_b32 a254, v236
v_accvgpr_write_b32 a255, v236
v_mov_b32 v244, v209
v_mov_b32 v245, 0
s_mov_b32 s6, 0x8000000
s_mov_b32 s7, 0x20000
s_mov_b32 s10, 0x8000000
s_mov_b32 s11, 0x20000
s_mov_b32 s18, 0x480000
s_mov_b32 s19, 0x20000
s_mov_b32 s26, 0x1408000
s_mov_b32 s27, 0x20000
s_mov_b32 s30, 0x240000
s_mov_b32 s31, 0x20000
s_mov_b32 s34, 0x100
s_mov_b32 s35, 0x20000
s_mov_b32 s88, s8
s_mov_b32 s89, s9
s_mov_b32 s90, s10
s_mov_b32 s91, s11
s_cmp_lg_u32 s36, 0
s_cbranch_scc1 L_noinit
s_lshl_b32 s50, s2, 7
s_add_u32 s50, s50, 0x1400000
v_mov_b32 v234, 0
v_lshrrev_b32 v235, 2, v240
v_cmp_gt_u32 vcc, 256, v240
s_nop 3
s_and_saveexec_b64 s[54:55], vcc
buffer_store_dword v234, v235, s[24:27], s50 offen sc1
s_mov_b64 exec, s[54:55]
L_noinit:
s_and_b32 s58, s38, 1
s_cmp_eq_u32 s58, 0
s_cbranch_scc1 L_nopf
s_lshr_b32 s59, s38, 1
s_lshl_b32 s59, s59, 2
s_add_u32 s59, s59, s36
s_mul_i32 s59, s59, 20
s_add_u32 s58, s59, 20
s_add_u32 m0, s37, 147456
L_pf:
s_cmp_ge_u32 s59, 576
s_cbranch_scc1 L_pfo
s_lshl_b32 s56, s59, 13
s_lshl_b32 s57, s39, 10
s_add_u32 s56, s56, s57
buffer_load_dwordx4 v240, s[12:15], s56 offen lds
s_branch L_pfn
L_pfo:
s_sub_u32 s56, s59, 576
s_lshl_b32 s56, s56, 10
s_mul_i32 s57, s39, 589824
s_add_u32 s56, s56, s57
buffer_load_dwordx4 v240, s[16:19], s56 offen lds
L_pfn:
s_waitcnt vmcnt(2)
s_add_u32 s59, s59, 1
s_cmp_lt_u32 s59, s58
s_cbranch_scc1 L_pf
s_waitcnt vmcnt(0)
L_nopf:
s_mov_b32 s53, 1
s_mov_b32 s44, 0
s_branch L_Q
L_K:
v_mov_b32 v230, 0xff800000
s_waitcnt vmcnt(16)
s_barrier
v_mov_b32 v218, v226
v_xor_b32 v219, 64, v218
v_xor_b32 v220, 128, v218
v_xor_b32 v221, 192, v218
ds_read_b128 v[160:163], v218 offset:0
ds_read_b128 v[164:167], v219 offset:0
ds_read_b128 v[168:171], v220 offset:0
ds_read_b128 v[172:175], v221 offset:0
ds_read_b128 v[176:179], v218 offset:1024
ds_read_b128 v[180:183], v219 offset:1024
v_cvt_pk_bf16_f32 v232, v128, v129
v_cvt_pk_bf16_f32 v233, v130, v131
v_cvt_pk_bf16_f32 v234, v132, v133
v_cvt_pk_bf16_f32 v235, v134, v135
v_cndmask_b32 v128, v232, v234, s[46:47]
v_cndmask_b32 v129, v233, v235, s[46:47]
v_cndmask_b32 v130, v234, v232, s[46:47]
v_cndmask_b32 v131, v235, v233, s[46:47]
v_cvt_pk_bf16_f32 v236, v136, v137
v_cvt_pk_bf16_f32 v237, v138, v139
v_cvt_pk_bf16_f32 v238, v140, v141
v_cvt_pk_bf16_f32 v239, v142, v143
v_cndmask_b32 v136, v236, v238, s[46:47]
v_cndmask_b32 v137, v237, v239, s[46:47]
v_cndmask_b32 v138, v238, v236, s[46:47]
v_cndmask_b32 v139, v239, v237, s[46:47]
v_cvt_pk_bf16_f32 v232, v144, v145
v_cvt_pk_bf16_f32 v233, v146, v147
v_cvt_pk_bf16_f32 v234, v148, v149
v_cvt_pk_bf16_f32 v235, v150, v151
v_cndmask_b32 v144, v232, v234, s[46:47]
v_cndmask_b32 v145, v233, v235, s[46:47]
v_cndmask_b32 v146, v234, v232, s[46:47]
v_cndmask_b32 v147, v235, v233, s[46:47]
v_cvt_pk_bf16_f32 v236, v152, v153
v_cvt_pk_bf16_f32 v237, v154, v155
v_cvt_pk_bf16_f32 v238, v156, v157
v_cvt_pk_bf16_f32 v239, v158, v159
v_cndmask_b32 v152, v236, v238, s[46:47]
v_cndmask_b32 v153, v237, v239, s[46:47]
v_cndmask_b32 v154, v238, v236, s[46:47]
v_cndmask_b32 v155, v239, v237, s[46:47]
s_waitcnt lgkmcnt(4)
v_mfma_f32_16x16x32_bf16 v[0:3], v[160:163], v[128:131], 0
ds_read_b128 v[184:187], v220 offset:1024
v_mfma_f32_16x16x32_bf16 v[0:3], v[164:167], v[136:139], v[0:3]
s_add_u32 m0, s37, 81920
s_add_u32 s49, s40, 81920
buffer_load_dwordx4 v208, s[4:7], s49 offen nt lds
ds_read_b128 v[188:191], v221 offset:1024
s_waitcnt lgkmcnt(4)
v_mfma_f32_16x16x32_bf16 v[0:3], v[168:171], v[144:147], v[0:3]
ds_read_b128 v[192:195], v218 offset:2048
v_mfma_f32_16x16x32_bf16 v[0:3], v[172:175], v[152:155], v[0:3]
ds_read_b128 v[196:199], v219 offset:2048
s_waitcnt lgkmcnt(4)
v_mfma_f32_16x16x32_bf16 v[4:7], v[176:179], v[128:131], 0
ds_read_b128 v[200:203], v220 offset:2048
v_mfma_f32_16x16x32_bf16 v[4:7], v[180:183], v[136:139], v[4:7]
buffer_load_dwordx4 v208, s[4:7], s49 offen offset:1024 nt lds
ds_read_b128 v[204:207], v221 offset:2048
s_waitcnt lgkmcnt(4)
v_mfma_f32_16x16x32_bf16 v[4:7], v[184:187], v[144:147], v[4:7]
ds_read_b128 v[160:163], v218 offset:3072
v_mfma_f32_16x16x32_bf16 v[4:7], v[188:191], v[152:155], v[4:7]
ds_read_b128 v[164:167], v219 offset:3072
s_waitcnt lgkmcnt(4)
v_mfma_f32_16x16x32_bf16 v[8:11], v[192:195], v[128:131], 0
ds_read_b128 v[168:171], v220 offset:3072
v_max3_f32 v230, v0, v1, v230
v_mfma_f32_16x16x32_bf16 v[8:11], v[196:199], v[136:139], v[8:11]
buffer_load_dwordx4 v208, s[4:7], s49 offen offset:2048 nt lds
ds_read_b128 v[172:175], v221 offset:3072
s_waitcnt lgkmcnt(4)
v_mfma_f32_16x16x32_bf16 v[8:11], v[200:203], v[144:147], v[8:11]
buffer_load_dwordx4 v208, s[4:7], s49 offen offset:3072 nt lds
s_waitcnt vmcnt(16)
s_barrier
ds_read_b128 v[176:179], v218 offset:16384
v_max3_f32 v230, v2, v3, v230
v_mfma_f32_16x16x32_bf16 v[8:11], v[204:207], v[152:155], v[8:11]
ds_read_b128 v[180:183], v219 offset:16384
s_waitcnt lgkmcnt(4)
v_mfma_f32_16x16x32_bf16 v[12:15], v[160:163], v[128:131], 0
ds_read_b128 v[184:187], v220 offset:16384
v_max3_f32 v230, v4, v5, v230
v_mfma_f32_16x16x32_bf16 v[12:15], v[164:167], v[136:139], v[12:15]
s_add_u32 m0, s37, 98304
s_add_u32 s48, s40, 98304
buffer_load_dwordx4 v208, s[4:7], s48 offen nt lds
ds_read_b128 v[188:191], v221 offset:16384
s_waitcnt lgkmcnt(4)
v_mfma_f32_16x16x32_bf16 v[12:15], v[168:171], v[144:147], v[12:15]
ds_read_b128 v[192:195], v218 offset:17408
v_max3_f32 v230, v6, v7, v230
v_mfma_f32_16x16x32_bf16 v[12:15], v[172:175], v[152:155], v[12:15]
ds_read_b128 v[196:199], v219 offset:17408
s_waitcnt lgkmcnt(4)
v_mfma_f32_16x16x32_bf16 v[16:19], v[176:179], v[128:131], 0
ds_read_b128 v[200:203], v220 offset:17408
v_max3_f32 v230, v8, v9, v230
v_mfma_f32_16x16x32_bf16 v[16:19], v[180:183], v[136:139], v[16:19]
buffer_load_dwordx4 v208, s[4:7], s48 offen offset:1024 nt lds
ds_read_b128 v[204:207], v221 offset:17408
s_waitcnt lgkmcnt(4)
v_mfma_f32_16x16x32_bf16 v[16:19], v[184:187], v[144:147], v[16:19]
ds_read_b128 v[160:163], v218 offset:18432
v_max3_f32 v230, v10, v11, v230
v_mfma_f32_16x16x32_bf16 v[16:19], v[188:191], v[152:155], v[16:19]
ds_read_b128 v[164:167], v219 offset:18432
s_waitcnt lgkmcnt(4)
v_mfma_f32_16x16x32_bf16 v[20:23], v[192:195], v[128:131], 0
ds_read_b128 v[168:171], v220 offset:18432
v_max3_f32 v230, v12, v13, v230
v_mfma_f32_16x16x32_bf16 v[20:23], v[196:199], v[136:139], v[20:23]
buffer_load_dwordx4 v208, s[4:7], s48 offen offset:2048 nt lds
ds_read_b128 v[172:175], v221 offset:18432
s_waitcnt lgkmcnt(4)
v_mfma_f32_16x16x32_bf16 v[20:23], v[200:203], v[144:147], v[20:23]
ds_read_b128 v[176:179], v218 offset:19456
v_max3_f32 v230, v14, v15, v230
v_mfma_f32_16x16x32_bf16 v[20:23], v[204:207], v[152:155], v[20:23]
ds_read_b128 v[180:183], v219 offset:19456
s_waitcnt lgkmcnt(4)
v_mfma_f32_16x16x32_bf16 v[24:27], v[160:163], v[128:131], 0
ds_read_b128 v[184:187], v220 offset:19456
v_max3_f32 v230, v16, v17, v230
v_mfma_f32_16x16x32_bf16 v[24:27], v[164:167], v[136:139], v[24:27]
buffer_load_dwordx4 v208, s[4:7], s48 offen offset:3072 nt lds
ds_read_b128 v[188:191], v221 offset:19456
s_waitcnt lgkmcnt(4)
v_mfma_f32_16x16x32_bf16 v[24:27], v[168:171], v[144:147], v[24:27]
s_waitcnt vmcnt(16)
s_barrier
ds_read_b128 v[192:195], v218 offset:32768
v_max3_f32 v230, v18, v19, v230
v_mfma_f32_16x16x32_bf16 v[24:27], v[172:175], v[152:155], v[24:27]
ds_read_b128 v[196:199], v219 offset:32768
s_waitcnt lgkmcnt(4)
v_mfma_f32_16x16x32_bf16 v[28:31], v[176:179], v[128:131], 0
ds_read_b128 v[200:203], v220 offset:32768
v_max3_f32 v230, v20, v21, v230
v_mfma_f32_16x16x32_bf16 v[28:31], v[180:183], v[136:139], v[28:31]
s_add_u32 m0, s37, 114688
s_add_u32 s49, s40, 114688
buffer_load_dwordx4 v208, s[4:7], s49 offen nt lds
ds_read_b128 v[204:207], v221 offset:32768
s_waitcnt lgkmcnt(4)
v_mfma_f32_16x16x32_bf16 v[28:31], v[184:187], v[144:147], v[28:31]
ds_read_b128 v[160:163], v218 offset:33792
v_max3_f32 v230, v22, v23, v230
v_mfma_f32_16x16x32_bf16 v[28:31], v[188:191], v[152:155], v[28:31]
ds_read_b128 v[164:167], v219 offset:33792
s_waitcnt lgkmcnt(4)
v_mfma_f32_16x16x32_bf16 v[32:35], v[192:195], v[128:131], 0
ds_read_b128 v[168:171], v220 offset:33792
v_max3_f32 v230, v24, v25, v230
v_mfma_f32_16x16x32_bf16 v[32:35], v[196:199], v[136:139], v[32:35]
buffer_load_dwordx4 v208, s[4:7], s49 offen offset:1024 nt lds
ds_read_b128 v[172:175], v221 offset:33792
s_waitcnt lgkmcnt(4)
v_mfma_f32_16x16x32_bf16 v[32:35], v[200:203], v[144:147], v[32:35]
ds_read_b128 v[176:179], v218 offset:34816
v_max3_f32 v230, v26, v27, v230
v_mfma_f32_16x16x32_bf16 v[32:35], v[204:207], v[152:155], v[32:35]
ds_read_b128 v[180:183], v219 offset:34816
s_waitcnt lgkmcnt(4)
v_mfma_f32_16x16x32_bf16 v[36:39], v[160:163], v[128:131], 0
ds_read_b128 v[184:187], v220 offset:34816
v_max3_f32 v230, v28, v29, v230
v_mfma_f32_16x16x32_bf16 v[36:39], v[164:167], v[136:139], v[36:39]
buffer_load_dwordx4 v208, s[4:7], s49 offen offset:2048 nt lds
ds_read_b128 v[188:191], v221 offset:34816
s_waitcnt lgkmcnt(4)
v_mfma_f32_16x16x32_bf16 v[36:39], v[168:171], v[144:147], v[36:39]
ds_read_b128 v[192:195], v218 offset:35840
v_max3_f32 v230, v30, v31, v230
v_mfma_f32_16x16x32_bf16 v[36:39], v[172:175], v[152:155], v[36:39]
ds_read_b128 v[196:199], v219 offset:35840
s_waitcnt lgkmcnt(4)
v_mfma_f32_16x16x32_bf16 v[40:43], v[176:179], v[128:131], 0
ds_read_b128 v[200:203], v220 offset:35840
v_max3_f32 v230, v32, v33, v230
v_mfma_f32_16x16x32_bf16 v[40:43], v[180:183], v[136:139], v[40:43]
buffer_load_dwordx4 v208, s[4:7], s49 offen offset:3072 nt lds
ds_read_b128 v[204:207], v221 offset:35840
s_waitcnt lgkmcnt(4)
v_mfma_f32_16x16x32_bf16 v[40:43], v[184:187], v[144:147], v[40:43]
s_waitcnt vmcnt(16)
s_barrier
ds_read_b128 v[160:163], v218 offset:49152
v_max3_f32 v230, v34, v35, v230
v_mfma_f32_16x16x32_bf16 v[40:43], v[188:191], v[152:155], v[40:43]
ds_read_b128 v[164:167], v219 offset:49152
s_waitcnt lgkmcnt(4)
v_mfma_f32_16x16x32_bf16 v[44:47], v[192:195], v[128:131], 0
ds_read_b128 v[168:171], v220 offset:49152
v_max3_f32 v230, v36, v37, v230
v_mfma_f32_16x16x32_bf16 v[44:47], v[196:199], v[136:139], v[44:47]
s_add_u32 m0, s37, 131072
s_add_u32 s48, s40, 0
buffer_load_dwordx4 v244, s[88:91], s48 offen nt lds
ds_read_b128 v[172:175], v221 offset:49152
s_waitcnt lgkmcnt(4)
v_mfma_f32_16x16x32_bf16 v[44:47], v[200:203], v[144:147], v[44:47]
ds_read_b128 v[176:179], v218 offset:50176
v_max3_f32 v230, v38, v39, v230
v_mfma_f32_16x16x32_bf16 v[44:47], v[204:207], v[152:155], v[44:47]
ds_read_b128 v[180:183], v219 offset:50176
s_waitcnt lgkmcnt(4)
v_mfma_f32_16x16x32_bf16 v[48:51], v[160:163], v[128:131], 0
ds_read_b128 v[184:187], v220 offset:50176
v_max3_f32 v230, v40, v41, v230
v_mfma_f32_16x16x32_bf16 v[48:51], v[164:167], v[136:139], v[48:51]
buffer_load_dwordx4 v244, s[88:91], s48 offen offset:1024 nt lds
ds_read_b128 v[188:191], v221 offset:50176
s_waitcnt lgkmcnt(4)
v_mfma_f32_16x16x32_bf16 v[48:51], v[168:171], v[144:147], v[48:51]
ds_read_b128 v[192:195], v218 offset:51200
v_max3_f32 v230, v42, v43, v230
v_mfma_f32_16x16x32_bf16 v[48:51], v[172:175], v[152:155], v[48:51]
ds_read_b128 v[196:199], v219 offset:51200
s_waitcnt lgkmcnt(4)
v_mfma_f32_16x16x32_bf16 v[52:55], v[176:179], v[128:131], 0
ds_read_b128 v[200:203], v220 offset:51200
v_max3_f32 v230, v44, v45, v230
v_mfma_f32_16x16x32_bf16 v[52:55], v[180:183], v[136:139], v[52:55]
buffer_load_dwordx4 v244, s[88:91], s48 offen offset:2048 nt lds
ds_read_b128 v[204:207], v221 offset:51200
s_waitcnt lgkmcnt(4)
v_mfma_f32_16x16x32_bf16 v[52:55], v[184:187], v[144:147], v[52:55]
ds_read_b128 v[160:163], v218 offset:52224
v_max3_f32 v230, v46, v47, v230
v_mfma_f32_16x16x32_bf16 v[52:55], v[188:191], v[152:155], v[52:55]
ds_read_b128 v[164:167], v219 offset:52224
s_waitcnt lgkmcnt(4)
v_mfma_f32_16x16x32_bf16 v[56:59], v[192:195], v[128:131], 0
ds_read_b128 v[168:171], v220 offset:52224
v_max3_f32 v230, v48, v49, v230
v_mfma_f32_16x16x32_bf16 v[56:59], v[196:199], v[136:139], v[56:59]
buffer_load_dwordx4 v244, s[88:91], s48 offen offset:3072 nt lds
ds_read_b128 v[172:175], v221 offset:52224
s_waitcnt lgkmcnt(4)
v_mfma_f32_16x16x32_bf16 v[56:59], v[200:203], v[144:147], v[56:59]
s_waitcnt vmcnt(16)
s_barrier
v_add_u32 v218, 65536, v226
v_xor_b32 v219, 64, v218
v_xor_b32 v220, 128, v218
v_xor_b32 v221, 192, v218
ds_read_b128 v[176:179], v218 offset:0
v_max3_f32 v230, v50, v51, v230
v_mfma_f32_16x16x32_bf16 v[56:59], v[204:207], v[152:155], v[56:59]
ds_read_b128 v[180:183], v219 offset:0
s_waitcnt lgkmcnt(4)
v_mfma_f32_16x16x32_bf16 v[60:63], v[160:163], v[128:131], 0
ds_read_b128 v[184:187], v220 offset:0
v_max3_f32 v230, v52, v53, v230
v_mfma_f32_16x16x32_bf16 v[60:63], v[164:167], v[136:139], v[60:63]
s_add_u32 m0, s37, 0
s_add_u32 s49, s40, 16384
buffer_load_dwordx4 v244, s[88:91], s49 offen nt lds
ds_read_b128 v[188:191], v221 offset:0
s_waitcnt lgkmcnt(4)
v_mfma_f32_16x16x32_bf16 v[60:63], v[168:171], v[144:147], v[60:63]
ds_read_b128 v[192:195], v218 offset:1024
v_max3_f32 v230, v54, v55, v230
v_mfma_f32_16x16x32_bf16 v[60:63], v[172:175], v[152:155], v[60:63]
ds_read_b128 v[196:199], v219 offset:1024
s_waitcnt lgkmcnt(4)
v_mfma_f32_16x16x32_bf16 v[64:67], v[176:179], v[128:131], 0
ds_read_b128 v[200:203], v220 offset:1024
v_max3_f32 v230, v56, v57, v230
v_mfma_f32_16x16x32_bf16 v[64:67], v[180:183], v[136:139], v[64:67]
buffer_load_dwordx4 v244, s[88:91], s49 offen offset:1024 nt lds
ds_read_b128 v[204:207], v221 offset:1024
s_waitcnt lgkmcnt(4)
v_mfma_f32_16x16x32_bf16 v[64:67], v[184:187], v[144:147], v[64:67]
ds_read_b128 v[160:163], v218 offset:2048
v_max3_f32 v230, v58, v59, v230
v_mfma_f32_16x16x32_bf16 v[64:67], v[188:191], v[152:155], v[64:67]
ds_read_b128 v[164:167], v219 offset:2048
s_waitcnt lgkmcnt(4)
v_mfma_f32_16x16x32_bf16 v[68:71], v[192:195], v[128:131], 0
ds_read_b128 v[168:171], v220 offset:2048
v_max3_f32 v230, v60, v61, v230
v_mfma_f32_16x16x32_bf16 v[68:71], v[196:199], v[136:139], v[68:71]
buffer_load_dwordx4 v244, s[88:91], s49 offen offset:2048 nt lds
ds_read_b128 v[172:175], v221 offset:2048
s_waitcnt lgkmcnt(4)
v_mfma_f32_16x16x32_bf16 v[68:71], v[200:203], v[144:147], v[68:71]
ds_read_b128 v[176:179], v218 offset:3072
v_max3_f32 v230, v62, v63, v230
v_mfma_f32_16x16x32_bf16 v[68:71], v[204:207], v[152:155], v[68:71]
ds_read_b128 v[180:183], v219 offset:3072
s_waitcnt lgkmcnt(4)
v_mfma_f32_16x16x32_bf16 v[72:75], v[160:163], v[128:131], 0
ds_read_b128 v[184:187], v220 offset:3072
v_max3_f32 v230, v64, v65, v230
v_mfma_f32_16x16x32_bf16 v[72:75], v[164:167], v[136:139], v[72:75]
buffer_load_dwordx4 v244, s[88:91], s49 offen offset:3072 nt lds
ds_read_b128 v[188:191], v221 offset:3072
s_waitcnt lgkmcnt(4)
v_mfma_f32_16x16x32_bf16 v[72:75], v[168:171], v[144:147], v[72:75]
s_waitcnt vmcnt(16)
s_barrier
ds_read_b128 v[192:195], v218 offset:16384
v_max3_f32 v230, v66, v67, v230
v_mfma_f32_16x16x32_bf16 v[72:75], v[172:175], v[152:155], v[72:75]
ds_read_b128 v[196:199], v219 offset:16384
s_waitcnt lgkmcnt(4)
v_mfma_f32_16x16x32_bf16 v[76:79], v[176:179], v[128:131], 0
ds_read_b128 v[200:203], v220 offset:16384
v_max3_f32 v230, v68, v69, v230
v_mfma_f32_16x16x32_bf16 v[76:79], v[180:183], v[136:139], v[76:79]
s_add_u32 m0, s37, 16384
s_add_u32 s48, s40, 32768
buffer_load_dwordx4 v244, s[88:91], s48 offen nt lds
ds_read_b128 v[204:207], v221 offset:16384
s_waitcnt lgkmcnt(4)
v_mfma_f32_16x16x32_bf16 v[76:79], v[184:187], v[144:147], v[76:79]
ds_read_b128 v[160:163], v218 offset:17408
v_max3_f32 v230, v70, v71, v230
v_mfma_f32_16x16x32_bf16 v[76:79], v[188:191], v[152:155], v[76:79]
ds_read_b128 v[164:167], v219 offset:17408
s_waitcnt lgkmcnt(4)
v_mfma_f32_16x16x32_bf16 v[80:83], v[192:195], v[128:131], 0
ds_read_b128 v[168:171], v220 offset:17408
v_max3_f32 v230, v72, v73, v230
v_mfma_f32_16x16x32_bf16 v[80:83], v[196:199], v[136:139], v[80:83]
buffer_load_dwordx4 v244, s[88:91], s48 offen offset:1024 nt lds
ds_read_b128 v[172:175], v221 offset:17408
s_waitcnt lgkmcnt(4)
v_mfma_f32_16x16x32_bf16 v[80:83], v[200:203], v[144:147], v[80:83]
ds_read_b128 v[176:179], v218 offset:18432
v_max3_f32 v230, v74, v75, v230
v_mfma_f32_16x16x32_bf16 v[80:83], v[204:207], v[152:155], v[80:83]
ds_read_b128 v[180:183], v219 offset:18432
s_waitcnt lgkmcnt(4)
v_mfma_f32_16x16x32_bf16 v[84:87], v[160:163], v[128:131], 0
ds_read_b128 v[184:187], v220 offset:18432
v_max3_f32 v230, v76, v77, v230
v_mfma_f32_16x16x32_bf16 v[84:87], v[164:167], v[136:139], v[84:87]
buffer_load_dwordx4 v244, s[88:91], s48 offen offset:2048 nt lds
ds_read_b128 v[188:191], v221 offset:18432
s_waitcnt lgkmcnt(4)
v_mfma_f32_16x16x32_bf16 v[84:87], v[168:171], v[144:147], v[84:87]
ds_read_b128 v[192:195], v218 offset:19456
v_max3_f32 v230, v78, v79, v230
v_mfma_f32_16x16x32_bf16 v[84:87], v[172:175], v[152:155], v[84:87]
ds_read_b128 v[196:199], v219 offset:19456
s_waitcnt lgkmcnt(4)
v_mfma_f32_16x16x32_bf16 v[88:91], v[176:179], v[128:131], 0
ds_read_b128 v[200:203], v220 offset:19456
v_max3_f32 v230, v80, v81, v230
v_mfma_f32_16x16x32_bf16 v[88:91], v[180:183], v[136:139], v[88:91]
buffer_load_dwordx4 v244, s[88:91], s48 offen offset:3072 nt lds
ds_read_b128 v[204:207], v221 offset:19456
s_waitcnt lgkmcnt(4)
v_mfma_f32_16x16x32_bf16 v[88:91], v[184:187], v[144:147], v[88:91]
s_waitcnt vmcnt(16)
s_barrier
ds_read_b128 v[160:163], v218 offset:32768
v_max3_f32 v230, v82, v83, v230
v_mfma_f32_16x16x32_bf16 v[88:91], v[188:191], v[152:155], v[88:91]
ds_read_b128 v[164:167], v219 offset:32768
s_waitcnt lgkmcnt(4)
v_mfma_f32_16x16x32_bf16 v[92:95], v[192:195], v[128:131], 0
ds_read_b128 v[168:171], v220 offset:32768
v_max3_f32 v230, v84, v85, v230
v_mfma_f32_16x16x32_bf16 v[92:95], v[196:199], v[136:139], v[92:95]
s_add_u32 m0, s37, 32768
s_add_u32 s49, s40, 49152
buffer_load_dwordx4 v244, s[88:91], s49 offen nt lds
ds_read_b128 v[172:175], v221 offset:32768
s_waitcnt lgkmcnt(4)
v_mfma_f32_16x16x32_bf16 v[92:95], v[200:203], v[144:147], v[92:95]
ds_read_b128 v[176:179], v218 offset:33792
v_max3_f32 v230, v86, v87, v230
v_mfma_f32_16x16x32_bf16 v[92:95], v[204:207], v[152:155], v[92:95]
ds_read_b128 v[180:183], v219 offset:33792
s_waitcnt lgkmcnt(4)
v_mfma_f32_16x16x32_bf16 v[96:99], v[160:163], v[128:131], 0
ds_read_b128 v[184:187], v220 offset:33792
v_max3_f32 v230, v88, v89, v230
v_mfma_f32_16x16x32_bf16 v[96:99], v[164:167], v[136:139], v[96:99]
buffer_load_dwordx4 v244, s[88:91], s49 offen offset:1024 nt lds
ds_read_b128 v[188:191], v221 offset:33792
s_waitcnt lgkmcnt(4)
v_mfma_f32_16x16x32_bf16 v[96:99], v[168:171], v[144:147], v[96:99]
ds_read_b128 v[192:195], v218 offset:34816
v_max3_f32 v230, v90, v91, v230
v_mfma_f32_16x16x32_bf16 v[96:99], v[172:175], v[152:155], v[96:99]
ds_read_b128 v[196:199], v219 offset:34816
s_waitcnt lgkmcnt(4)
v_mfma_f32_16x16x32_bf16 v[100:103], v[176:179], v[128:131], 0
ds_read_b128 v[200:203], v220 offset:34816
v_max3_f32 v230, v92, v93, v230
v_mfma_f32_16x16x32_bf16 v[100:103], v[180:183], v[136:139], v[100:103]
buffer_load_dwordx4 v244, s[88:91], s49 offen offset:2048 nt lds
ds_read_b128 v[204:207], v221 offset:34816
s_waitcnt lgkmcnt(4)
v_mfma_f32_16x16x32_bf16 v[100:103], v[184:187], v[144:147], v[100:103]
ds_read_b128 v[160:163], v218 offset:35840
v_max3_f32 v230, v94, v95, v230
v_mfma_f32_16x16x32_bf16 v[100:103], v[188:191], v[152:155], v[100:103]
ds_read_b128 v[164:167], v219 offset:35840
s_waitcnt lgkmcnt(4)
v_mfma_f32_16x16x32_bf16 v[104:107], v[192:195], v[128:131], 0
ds_read_b128 v[168:171], v220 offset:35840
v_max3_f32 v230, v96, v97, v230
v_mfma_f32_16x16x32_bf16 v[104:107], v[196:199], v[136:139], v[104:107]
buffer_load_dwordx4 v244, s[88:91], s49 offen offset:3072 nt lds
ds_read_b128 v[172:175], v221 offset:35840
s_waitcnt lgkmcnt(4)
v_mfma_f32_16x16x32_bf16 v[104:107], v[200:203], v[144:147], v[104:107]
s_waitcnt vmcnt(16)
s_barrier
ds_read_b128 v[176:179], v218 offset:49152
v_max3_f32 v230, v98, v99, v230
v_mfma_f32_16x16x32_bf16 v[104:107], v[204:207], v[152:155], v[104:107]
ds_read_b128 v[180:183], v219 offset:49152
s_waitcnt lgkmcnt(4)
v_mfma_f32_16x16x32_bf16 v[108:111], v[160:163], v[128:131], 0
ds_read_b128 v[184:187], v220 offset:49152
v_max3_f32 v230, v100, v101, v230
v_mfma_f32_16x16x32_bf16 v[108:111], v[164:167], v[136:139], v[108:111]
s_add_u32 m0, s37, 49152
s_add_u32 s48, s40, 65536
buffer_load_dwordx4 v244, s[88:91], s48 offen nt lds
ds_read_b128 v[188:191], v221 offset:49152
s_waitcnt lgkmcnt(4)
v_mfma_f32_16x16x32_bf16 v[108:111], v[168:171], v[144:147], v[108:111]
ds_read_b128 v[192:195], v218 offset:50176
v_max3_f32 v230, v102, v103, v230
v_mfma_f32_16x16x32_bf16 v[108:111], v[172:175], v[152:155], v[108:111]
ds_read_b128 v[196:199], v219 offset:50176
s_waitcnt lgkmcnt(4)
v_mfma_f32_16x16x32_bf16 v[112:115], v[176:179], v[128:131], 0
ds_read_b128 v[200:203], v220 offset:50176
v_max3_f32 v230, v104, v105, v230
v_mfma_f32_16x16x32_bf16 v[112:115], v[180:183], v[136:139], v[112:115]
buffer_load_dwordx4 v244, s[88:91], s48 offen offset:1024 nt lds
ds_read_b128 v[204:207], v221 offset:50176
s_waitcnt lgkmcnt(4)
v_mfma_f32_16x16x32_bf16 v[112:115], v[184:187], v[144:147], v[112:115]
ds_read_b128 v[160:163], v218 offset:51200
v_max3_f32 v230, v106, v107, v230
v_mfma_f32_16x16x32_bf16 v[112:115], v[188:191], v[152:155], v[112:115]
ds_read_b128 v[164:167], v219 offset:51200
s_waitcnt lgkmcnt(4)
v_mfma_f32_16x16x32_bf16 v[116:119], v[192:195], v[128:131], 0
ds_read_b128 v[168:171], v220 offset:51200
v_max3_f32 v230, v108, v109, v230
v_mfma_f32_16x16x32_bf16 v[116:119], v[196:199], v[136:139], v[116:119]
buffer_load_dwordx4 v244, s[88:91], s48 offen offset:2048 nt lds
ds_read_b128 v[172:175], v221 offset:51200
s_waitcnt lgkmcnt(4)
v_mfma_f32_16x16x32_bf16 v[116:119], v[200:203], v[144:147], v[116:119]
ds_read_b128 v[176:179], v218 offset:52224
v_max3_f32 v230, v110, v111, v230
v_mfma_f32_16x16x32_bf16 v[116:119], v[204:207], v[152:155], v[116:119]
ds_read_b128 v[180:183], v219 offset:52224
s_waitcnt lgkmcnt(4)
v_mfma_f32_16x16x32_bf16 v[120:123], v[160:163], v[128:131], 0
ds_read_b128 v[184:187], v220 offset:52224
v_max3_f32 v230, v112, v113, v230
v_mfma_f32_16x16x32_bf16 v[120:123], v[164:167], v[136:139], v[120:123]
buffer_load_dwordx4 v244, s[88:91], s48 offen offset:3072 nt lds
ds_read_b128 v[188:191], v221 offset:52224
s_waitcnt lgkmcnt(4)
v_mfma_f32_16x16x32_bf16 v[120:123], v[168:171], v[144:147], v[120:123]
s_waitcnt vmcnt(16)
s_barrier
v_add_u32 v218, 131072, v227
v_xor_b32 v219, 32, v218
v_xor_b32 v220, 64, v218
v_xor_b32 v221, 96, v218
v_xor_b32 v222, 128, v218
v_xor_b32 v223, 160, v218
v_xor_b32 v224, 192, v218
v_xor_b32 v225, 224, v218
ds_read_b64_tr_b16 v[192:193], v218 offset:0
v_max3_f32 v230, v114, v115, v230
v_mfma_f32_16x16x32_bf16 v[120:123], v[172:175], v[152:155], v[120:123]
ds_read_b64_tr_b16 v[194:195], v218 offset:1024
s_waitcnt lgkmcnt(4)
v_mfma_f32_16x16x32_bf16 v[124:127], v[176:179], v[128:131], 0
ds_read_b64_tr_b16 v[196:197], v219 offset:0
v_max3_f32 v230, v116, v117, v230
v_mfma_f32_16x16x32_bf16 v[124:127], v[180:183], v[136:139], v[124:127]
s_add_u32 m0, s37, 65536
s_add_u32 s49, s40, 81920
buffer_load_dwordx4 v244, s[88:91], s49 offen nt lds
ds_read_b64_tr_b16 v[198:199], v219 offset:1024
s_waitcnt lgkmcnt(4)
v_mfma_f32_16x16x32_bf16 v[124:127], v[184:187], v[144:147], v[124:127]
ds_read_b64_tr_b16 v[200:201], v220 offset:0
ds_read_b64_tr_b16 v[202:203], v220 offset:1024
v_max3_f32 v230, v118, v119, v230
v_mfma_f32_16x16x32_bf16 v[124:127], v[188:191], v[152:155], v[124:127]
ds_read_b64_tr_b16 v[204:205], v221 offset:0
ds_read_b64_tr_b16 v[206:207], v221 offset:1024
s_waitcnt lgkmcnt(4)
v_max3_f32 v230, v120, v121, v230
v_max3_f32 v230, v122, v123, v230
s_nop 2
v_max3_f32 v230, v124, v125, v230
v_max3_f32 v230, v126, v127, v230
v_mov_b32 v232, v230
s_nop 1
v_permlane32_swap_b32 v230, v232
v_max_f32 v230, v230, v232
v_mov_b32 v232, v230
s_nop 1
v_permlane16_swap_b32 v230, v232
v_max_f32 v230, v230, v232
v_mul_f32 v231, s45, v230
v_fma_f32 v0, v0, s45, -v231
v_fma_f32 v1, v1, s45, -v231
v_fma_f32 v2, v2, s45, -v231
v_fma_f32 v3, v3, s45, -v231
v_fma_f32 v4, v4, s45, -v231
v_fma_f32 v5, v5, s45, -v231
v_fma_f32 v6, v6, s45, -v231
v_fma_f32 v7, v7, s45, -v231
v_exp_f32 v0, v0
v_exp_f32 v1, v1
v_exp_f32 v2, v2
v_exp_f32 v3, v3
v_exp_f32 v4, v4
v_exp_f32 v5, v5
v_exp_f32 v6, v6
v_exp_f32 v7, v7
v_cvt_pk_bf16_f32 v0, v0, v1
v_cvt_pk_bf16_f32 v1, v2, v3
v_cvt_pk_bf16_f32 v2, v4, v5
v_cvt_pk_bf16_f32 v3, v6, v7
v_fma_f32 v8, v8, s45, -v231
v_fma_f32 v9, v9, s45, -v231
v_fma_f32 v10, v10, s45, -v231
v_fma_f32 v11, v11, s45, -v231
v_fma_f32 v12, v12, s45, -v231
v_fma_f32 v13, v13, s45, -v231
v_fma_f32 v14, v14, s45, -v231
v_fma_f32 v15, v15, s45, -v231
v_exp_f32 v8, v8
v_exp_f32 v9, v9
v_exp_f32 v10, v10
v_exp_f32 v11, v11
v_exp_f32 v12, v12
v_exp_f32 v13, v13
v_exp_f32 v14, v14
v_exp_f32 v15, v15
v_cvt_pk_bf16_f32 v8, v8, v9
v_cvt_pk_bf16_f32 v9, v10, v11
v_cvt_pk_bf16_f32 v10, v12, v13
v_cvt_pk_bf16_f32 v11, v14, v15
v_mfma_f32_16x16x32_bf16 a[216:219], v[192:195], v[0:3], 0
ds_read_b64_tr_b16 v[160:161], v222 offset:0
ds_read_b64_tr_b16 v[162:163], v222 offset:1024
v_fma_f32 v16, v16, s45, -v231
v_fma_f32 v17, v17, s45, -v231
v_fma_f32 v18, v18, s45, -v231
v_mfma_f32_16x16x32_bf16 a[220:223], v[196:199], v[0:3], 0
buffer_load_dwordx4 v244, s[88:91], s49 offen offset:1024 nt lds
ds_read_b64_tr_b16 v[164:165], v223 offset:0
ds_read_b64_tr_b16 v[166:167], v223 offset:1024
s_waitcnt lgkmcnt(4)
v_fma_f32 v19, v19, s45, -v231
v_fma_f32 v20, v20, s45, -v231
v_mfma_f32_16x16x32_bf16 a[224:227], v[200:203], v[0:3], 0
ds_read_b64_tr_b16 v[168:169], v224 offset:0
ds_read_b64_tr_b16 v[170:171], v224 offset:1024
v_fma_f32 v21, v21, s45, -v231
v_fma_f32 v22, v22, s45, -v231
v_mfma_f32_16x16x32_bf16 a[228:231], v[204:207], v[0:3], 0
ds_read_b64_tr_b16 v[172:173], v225 offset:0
ds_read_b64_tr_b16 v[174:175], v225 offset:1024
s_waitcnt lgkmcnt(4)
v_fma_f32 v23, v23, s45, -v231
v_exp_f32 v16, v16
v_mfma_f32_16x16x32_bf16 a[232:235], v[160:163], v[0:3], 0
buffer_load_dwordx4 v244, s[88:91], s49 offen offset:2048 nt lds
ds_read_b64_tr_b16 v[176:177], v218 offset:2048
ds_read_b64_tr_b16 v[178:179], v218 offset:3072
v_exp_f32 v17, v17
v_exp_f32 v18, v18
v_mfma_f32_16x16x32_bf16 a[236:239], v[164:167], v[0:3], 0
ds_read_b64_tr_b16 v[180:181], v219 offset:2048
ds_read_b64_tr_b16 v[182:183], v219 offset:3072
s_waitcnt lgkmcnt(4)
v_exp_f32 v19, v19
v_exp_f32 v20, v20
v_mfma_f32_16x16x32_bf16 a[240:243], v[168:171], v[0:3], 0
ds_read_b64_tr_b16 v[184:185], v220 offset:2048
ds_read_b64_tr_b16 v[186:187], v220 offset:3072
v_exp_f32 v21, v21
v_exp_f32 v22, v22
v_mfma_f32_16x16x32_bf16 a[244:247], v[172:175], v[0:3], 0
ds_read_b64_tr_b16 v[188:189], v221 offset:2048
ds_read_b64_tr_b16 v[190:191], v221 offset:3072
v_exp_f32 v23, v23
v_cvt_pk_bf16_f32 v16, v16, v17
v_cvt_pk_bf16_f32 v17, v18, v19
v_mfma_f32_16x16x32_bf16 a[248:251], a[252:255], v[0:3], 0
ds_read_b64_tr_b16 v[192:193], v222 offset:2048
ds_read_b64_tr_b16 v[194:195], v222 offset:3072
s_waitcnt lgkmcnt(6)
v_cvt_pk_bf16_f32 v18, v20, v21
v_cvt_pk_bf16_f32 v19, v22, v23
v_mfma_f32_16x16x32_bf16 a[216:219], v[176:179], v[8:11], a[216:219]
ds_read_b64_tr_b16 v[196:197], v223 offset:2048
ds_read_b64_tr_b16 v[198:199], v223 offset:3072
v_fma_f32 v24, v24, s45, -v231
v_fma_f32 v25, v25, s45, -v231
v_mfma_f32_16x16x32_bf16 a[220:223], v[180:183], v[8:11], a[220:223]
buffer_load_dwordx4 v244, s[88:91], s49 offen offset:3072 nt lds
ds_read_b64_tr_b16 v[200:201], v224 offset:2048
ds_read_b64_tr_b16 v[202:203], v224 offset:3072
s_waitcnt lgkmcnt(6)
v_fma_f32 v26, v26, s45, -v231
v_fma_f32 v27, v27, s45, -v231
v_mfma_f32_16x16x32_bf16 a[224:227], v[184:187], v[8:11], a[224:227]
ds_read_b64_tr_b16 v[204:205], v225 offset:2048
ds_read_b64_tr_b16 v[206:207], v225 offset:3072
v_fma_f32 v28, v28, s45, -v231
v_fma_f32 v29, v29, s45, -v231
v_mfma_f32_16x16x32_bf16 a[228:231], v[188:191], v[8:11], a[228:231]
s_waitcnt vmcnt(16)
s_barrier
v_mov_b32 v218, v227
v_xor_b32 v219, 32, v218
v_xor_b32 v220, 64, v218
v_xor_b32 v221, 96, v218
v_xor_b32 v222, 128, v218
v_xor_b32 v223, 160, v218
v_xor_b32 v224, 192, v218
v_xor_b32 v225, 224, v218
ds_read_b64_tr_b16 v[160:161], v218 offset:0
ds_read_b64_tr_b16 v[162:163], v218 offset:1024
s_waitcnt lgkmcnt(6)
v_fma_f32 v30, v30, s45, -v231
v_fma_f32 v31, v31, s45, -v231
v_mfma_f32_16x16x32_bf16 a[232:235], v[192:195], v[8:11], a[232:235]
s_add_u32 m0, s37, 81920
s_add_u32 s48, s40, 98304
buffer_load_dwordx4 v244, s[88:91], s48 offen nt lds
ds_read_b64_tr_b16 v[164:165], v219 offset:0
ds_read_b64_tr_b16 v[166:167], v219 offset:1024
v_exp_f32 v24, v24
v_exp_f32 v25, v25
v_mfma_f32_16x16x32_bf16 a[236:239], v[196:199], v[8:11], a[236:239]
ds_read_b64_tr_b16 v[168:169], v220 offset:0
ds_read_b64_tr_b16 v[170:171], v220 offset:1024
s_waitcnt lgkmcnt(6)
v_exp_f32 v26, v26
v_exp_f32 v27, v27
v_exp_f32 v28, v28
v_mfma_f32_16x16x32_bf16 a[240:243], v[200:203], v[8:11], a[240:243]
ds_read_b64_tr_b16 v[172:173], v221 offset:0
ds_read_b64_tr_b16 v[174:175], v221 offset:1024
v_exp_f32 v29, v29
v_exp_f32 v30, v30
v_mfma_f32_16x16x32_bf16 a[244:247], v[204:207], v[8:11], a[244:247]
v_exp_f32 v31, v31
v_cvt_pk_bf16_f32 v24, v24, v25
v_mfma_f32_16x16x32_bf16 a[248:251], a[252:255], v[8:11], a[248:251]
ds_read_b64_tr_b16 v[176:177], v222 offset:0
ds_read_b64_tr_b16 v[178:179], v222 offset:1024
s_waitcnt lgkmcnt(6)
v_cvt_pk_bf16_f32 v25, v26, v27
v_cvt_pk_bf16_f32 v26, v28, v29
v_mfma_f32_16x16x32_bf16 a[216:219], v[160:163], v[16:19], a[216:219]
ds_read_b64_tr_b16 v[180:181], v223 offset:0
ds_read_b64_tr_b16 v[182:183], v223 offset:1024
v_cvt_pk_bf16_f32 v27, v30, v31
v_fma_f32 v32, v32, s45, -v231
v_mfma_f32_16x16x32_bf16 a[220:223], v[164:167], v[16:19], a[220:223]
buffer_load_dwordx4 v244, s[88:91], s48 offen offset:1024 nt lds
ds_read_b64_tr_b16 v[184:185], v224 offset:0
ds_read_b64_tr_b16 v[186:187], v224 offset:1024
s_waitcnt lgkmcnt(6)
v_fma_f32 v33, v33, s45, -v231
v_fma_f32 v34, v34, s45, -v231
v_mfma_f32_16x16x32_bf16 a[224:227], v[168:171], v[16:19], a[224:227]
ds_read_b64_tr_b16 v[188:189], v225 offset:0
ds_read_b64_tr_b16 v[190:191], v225 offset:1024
v_fma_f32 v35, v35, s45, -v231
v_fma_f32 v36, v36, s45, -v231
v_mfma_f32_16x16x32_bf16 a[228:231], v[172:175], v[16:19], a[228:231]
ds_read_b64_tr_b16 v[192:193], v218 offset:2048
ds_read_b64_tr_b16 v[194:195], v218 offset:3072
s_waitcnt lgkmcnt(6)
v_fma_f32 v37, v37, s45, -v231
v_fma_f32 v38, v38, s45, -v231
v_fma_f32 v39, v39, s45, -v231
v_mfma_f32_16x16x32_bf16 a[232:235], v[176:179], v[16:19], a[232:235]
buffer_load_dwordx4 v244, s[88:91], s48 offen offset:2048 nt lds
ds_read_b64_tr_b16 v[196:197], v219 offset:2048
ds_read_b64_tr_b16 v[198:199], v219 offset:3072
v_exp_f32 v32, v32
v_exp_f32 v33, v33
v_mfma_f32_16x16x32_bf16 a[236:239], v[180:183], v[16:19], a[236:239]
ds_read_b64_tr_b16 v[200:201], v220 offset:2048
ds_read_b64_tr_b16 v[202:203], v220 offset:3072
s_waitcnt lgkmcnt(6)
v_exp_f32 v34, v34
v_exp_f32 v35, v35
s_cmp_lg_u32 s44, 3
s_cbranch_scc1 L_nochk
s_cmp_lg_u32 s36, 0
s_cbranch_scc1 L_nochk
s_lshl_b32 s50, s38, 3
s_add_u32 s50, s50, 4
v_mov_b32 v239, 0
buffer_load_dword v245, v239, s[32:35], s50 offen sc1
L_nochk:
v_mfma_f32_16x16x32_bf16 a[240:243], v[184:187], v[16:19], a[240:243]
ds_read_b64_tr_b16 v[204:205], v221 offset:2048
ds_read_b64_tr_b16 v[206:207], v221 offset:3072
v_exp_f32 v36, v36
v_exp_f32 v37, v37
v_mfma_f32_16x16x32_bf16 a[244:247], v[188:191], v[16:19], a[244:247]
v_exp_f32 v38, v38
v_exp_f32 v39, v39
v_mfma_f32_16x16x32_bf16 a[248:251], a[252:255], v[16:19], a[248:251]
ds_read_b64_tr_b16 v[160:161], v222 offset:2048
ds_read_b64_tr_b16 v[162:163], v222 offset:3072
s_waitcnt lgkmcnt(6)
v_cvt_pk_bf16_f32 v32, v32, v33
v_cvt_pk_bf16_f32 v33, v34, v35
v_mfma_f32_16x16x32_bf16 a[216:219], v[192:195], v[24:27], a[216:219]
ds_read_b64_tr_b16 v[164:165], v223 offset:2048
ds_read_b64_tr_b16 v[166:167], v223 offset:3072
v_cvt_pk_bf16_f32 v34, v36, v37
v_cvt_pk_bf16_f32 v35, v38, v39
v_mfma_f32_16x16x32_bf16 a[220:223], v[196:199], v[24:27], a[220:223]
buffer_load_dwordx4 v244, s[88:91], s48 offen offset:3072 nt lds
ds_read_b64_tr_b16 v[168:169], v224 offset:2048
ds_read_b64_tr_b16 v[170:171], v224 offset:3072
s_waitcnt lgkmcnt(6)
v_fma_f32 v40, v40, s45, -v231
v_fma_f32 v41, v41, s45, -v231
v_mfma_f32_16x16x32_bf16 a[224:227], v[200:203], v[24:27], a[224:227]
ds_read_b64_tr_b16 v[172:173], v225 offset:2048
ds_read_b64_tr_b16 v[174:175], v225 offset:3072
v_fma_f32 v42, v42, s45, -v231
v_fma_f32 v43, v43, s45, -v231
v_fma_f32 v44, v44, s45, -v231
v_mfma_f32_16x16x32_bf16 a[228:231], v[204:207], v[24:27], a[228:231]
s_waitcnt vmcnt(16)
s_barrier
ds_read_b64_tr_b16 v[176:177], v218 offset:16384
ds_read_b64_tr_b16 v[178:179], v218 offset:17408
s_waitcnt lgkmcnt(6)
v_fma_f32 v45, v45, s45, -v231
v_fma_f32 v46, v46, s45, -v231
v_mfma_f32_16x16x32_bf16 a[232:235], v[160:163], v[24:27], a[232:235]
s_add_u32 m0, s37, 98304
s_add_u32 s49, s40, 114688
buffer_load_dwordx4 v244, s[88:91], s49 offen nt lds
ds_read_b64_tr_b16 v[180:181], v219 offset:16384
ds_read_b64_tr_b16 v[182:183], v219 offset:17408
v_fma_f32 v47, v47, s45, -v231
v_exp_f32 v40, v40
v_mfma_f32_16x16x32_bf16 a[236:239], v[164:167], v[24:27], a[236:239]
ds_read_b64_tr_b16 v[184:185], v220 offset:16384
ds_read_b64_tr_b16 v[186:187], v220 offset:17408
s_waitcnt lgkmcnt(6)
v_exp_f32 v41, v41
v_exp_f32 v42, v42
v_mfma_f32_16x16x32_bf16 a[240:243], v[168:171], v[24:27], a[240:243]
ds_read_b64_tr_b16 v[188:189], v221 offset:16384
ds_read_b64_tr_b16 v[190:191], v221 offset:17408
v_exp_f32 v43, v43
v_exp_f32 v44, v44
v_mfma_f32_16x16x32_bf16 a[244:247], v[172:175], v[24:27], a[244:247]
v_exp_f32 v45, v45
v_exp_f32 v46, v46
v_mfma_f32_16x16x32_bf16 a[248:251], a[252:255], v[24:27], a[248:251]
ds_read_b64_tr_b16 v[192:193], v222 offset:16384
ds_read_b64_tr_b16 v[194:195], v222 offset:17408
s_waitcnt lgkmcnt(6)
v_exp_f32 v47, v47
v_cvt_pk_bf16_f32 v40, v40, v41
v_mfma_f32_16x16x32_bf16 a[216:219], v[176:179], v[32:35], a[216:219]
ds_read_b64_tr_b16 v[196:197], v223 offset:16384
ds_read_b64_tr_b16 v[198:199], v223 offset:17408
v_cvt_pk_bf16_f32 v41, v42, v43
v_cvt_pk_bf16_f32 v42, v44, v45
v_cvt_pk_bf16_f32 v43, v46, v47
v_mfma_f32_16x16x32_bf16 a[220:223], v[180:183], v[32:35], a[220:223]
buffer_load_dwordx4 v244, s[88:91], s49 offen offset:1024 nt lds
ds_read_b64_tr_b16 v[200:201], v224 offset:16384
ds_read_b64_tr_b16 v[202:203], v224 offset:17408
s_waitcnt lgkmcnt(6)
v_fma_f32 v48, v48, s45, -v231
v_fma_f32 v49, v49, s45, -v231
v_mfma_f32_16x16x32_bf16 a[224:227], v[184:187], v[32:35], a[224:227]
ds_read_b64_tr_b16 v[204:205], v225 offset:16384
ds_read_b64_tr_b16 v[206:207], v225 offset:17408
v_fma_f32 v50, v50, s45, -v231
v_fma_f32 v51, v51, s45, -v231
v_mfma_f32_16x16x32_bf16 a[228:231], v[188:191], v[32:35], a[228:231]
ds_read_b64_tr_b16 v[160:161], v218 offset:18432
ds_read_b64_tr_b16 v[162:163], v218 offset:19456
s_waitcnt lgkmcnt(6)
v_fma_f32 v52, v52, s45, -v231
v_fma_f32 v53, v53, s45, -v231
v_mfma_f32_16x16x32_bf16 a[232:235], v[192:195], v[32:35], a[232:235]
buffer_load_dwordx4 v244, s[88:91], s49 offen offset:2048 nt lds
ds_read_b64_tr_b16 v[164:165], v219 offset:18432
ds_read_b64_tr_b16 v[166:167], v219 offset:19456
v_fma_f32 v54, v54, s45, -v231
v_fma_f32 v55, v55, s45, -v231
v_mfma_f32_16x16x32_bf16 a[236:239], v[196:199], v[32:35], a[236:239]
ds_read_b64_tr_b16 v[168:169], v220 offset:18432
ds_read_b64_tr_b16 v[170:171], v220 offset:19456
s_waitcnt lgkmcnt(6)
v_exp_f32 v48, v48
v_exp_f32 v49, v49
v_mfma_f32_16x16x32_bf16 a[240:243], v[200:203], v[32:35], a[240:243]
ds_read_b64_tr_b16 v[172:173], v221 offset:18432
ds_read_b64_tr_b16 v[174:175], v221 offset:19456
v_exp_f32 v50, v50
v_exp_f32 v51, v51
v_mfma_f32_16x16x32_bf16 a[244:247], v[204:207], v[32:35], a[244:247]
v_exp_f32 v52, v52
v_exp_f32 v53, v53
v_exp_f32 v54, v54
v_mfma_f32_16x16x32_bf16 a[248:251], a[252:255], v[32:35], a[248:251]
ds_read_b64_tr_b16 v[176:177], v222 offset:18432
ds_read_b64_tr_b16 v[178:179], v222 offset:19456
s_waitcnt lgkmcnt(6)
v_exp_f32 v55, v55
v_cvt_pk_bf16_f32 v48, v48, v49
v_mfma_f32_16x16x32_bf16 a[216:219], v[160:163], v[40:43], a[216:219]
ds_read_b64_tr_b16 v[180:181], v223 offset:18432
ds_read_b64_tr_b16 v[182:183], v223 offset:19456
v_cvt_pk_bf16_f32 v49, v50, v51
v_cvt_pk_bf16_f32 v50, v52, v53
v_mfma_f32_16x16x32_bf16 a[220:223], v[164:167], v[40:43], a[220:223]
buffer_load_dwordx4 v244, s[88:91], s49 offen offset:3072 nt lds
ds_read_b64_tr_b16 v[184:185], v224 offset:18432
ds_read_b64_tr_b16 v[186:187], v224 offset:19456
s_waitcnt lgkmcnt(6)
v_cvt_pk_bf16_f32 v51, v54, v55
v_fma_f32 v56, v56, s45, -v231
v_mfma_f32_16x16x32_bf16 a[224:227], v[168:171], v[40:43], a[224:227]
ds_read_b64_tr_b16 v[188:189], v225 offset:18432
ds_read_b64_tr_b16 v[190:191], v225 offset:19456
v_fma_f32 v57, v57, s45, -v231
v_fma_f32 v58, v58, s45, -v231
v_mfma_f32_16x16x32_bf16 a[228:231], v[172:175], v[40:43], a[228:231]
s_waitcnt vmcnt(16)
s_barrier
ds_read_b64_tr_b16 v[192:193], v218 offset:32768
ds_read_b64_tr_b16 v[194:195], v218 offset:33792
s_waitcnt lgkmcnt(6)
v_fma_f32 v59, v59, s45, -v231
v_fma_f32 v60, v60, s45, -v231
v_mfma_f32_16x16x32_bf16 a[232:235], v[176:179], v[40:43], a[232:235]
s_add_u32 m0, s37, 114688
s_add_u32 s48, s43, 0
buffer_load_dwordx4 v214, s[16:19], s48 offen lds
ds_read_b64_tr_b16 v[196:197], v219 offset:32768
ds_read_b64_tr_b16 v[198:199], v219 offset:33792
v_fma_f32 v61, v61, s45, -v231
v_fma_f32 v62, v62, s45, -v231
v_mfma_f32_16x16x32_bf16 a[236:239], v[180:183], v[40:43], a[236:239]
ds_read_b64_tr_b16 v[200:201], v220 offset:32768
ds_read_b64_tr_b16 v[202:203], v220 offset:33792
s_waitcnt lgkmcnt(6)
v_fma_f32 v63, v63, s45, -v231
v_exp_f32 v56, v56
v_exp_f32 v57, v57
v_mfma_f32_16x16x32_bf16 a[240:243], v[184:187], v[40:43], a[240:243]
ds_read_b64_tr_b16 v[204:205], v221 offset:32768
ds_read_b64_tr_b16 v[206:207], v221 offset:33792
v_exp_f32 v58, v58
v_exp_f32 v59, v59
v_mfma_f32_16x16x32_bf16 a[244:247], v[188:191], v[40:43], a[244:247]
v_exp_f32 v60, v60
v_exp_f32 v61, v61
v_mfma_f32_16x16x32_bf16 a[248:251], a[252:255], v[40:43], a[248:251]
ds_read_b64_tr_b16 v[160:161], v222 offset:32768
ds_read_b64_tr_b16 v[162:163], v222 offset:33792
s_waitcnt lgkmcnt(6)
v_exp_f32 v62, v62
v_exp_f32 v63, v63
v_mfma_f32_16x16x32_bf16 a[216:219], v[192:195], v[48:51], a[216:219]
ds_read_b64_tr_b16 v[164:165], v223 offset:32768
ds_read_b64_tr_b16 v[166:167], v223 offset:33792
v_cvt_pk_bf16_f32 v56, v56, v57
v_cvt_pk_bf16_f32 v57, v58, v59
v_mfma_f32_16x16x32_bf16 a[220:223], v[196:199], v[48:51], a[220:223]
buffer_load_dwordx4 v215, s[16:19], s48 offen offset:1024 lds
ds_read_b64_tr_b16 v[168:169], v224 offset:32768
ds_read_b64_tr_b16 v[170:171], v224 offset:33792
s_waitcnt lgkmcnt(6)
v_cvt_pk_bf16_f32 v58, v60, v61
v_cvt_pk_bf16_f32 v59, v62, v63
v_mfma_f32_16x16x32_bf16 a[224:227], v[200:203], v[48:51], a[224:227]
ds_read_b64_tr_b16 v[172:173], v225 offset:32768
ds_read_b64_tr_b16 v[174:175], v225 offset:33792
v_fma_f32 v64, v64, s45, -v231
v_fma_f32 v65, v65, s45, -v231
v_mfma_f32_16x16x32_bf16 a[228:231], v[204:207], v[48:51], a[228:231]
ds_read_b64_tr_b16 v[176:177], v218 offset:34816
ds_read_b64_tr_b16 v[178:179], v218 offset:35840
s_waitcnt lgkmcnt(6)
v_fma_f32 v66, v66, s45, -v231
v_fma_f32 v67, v67, s45, -v231
v_mfma_f32_16x16x32_bf16 a[232:235], v[160:163], v[48:51], a[232:235]
buffer_load_dwordx4 v216, s[16:19], s48 offen offset:2048 lds
ds_read_b64_tr_b16 v[180:181], v219 offset:34816
ds_read_b64_tr_b16 v[182:183], v219 offset:35840
v_fma_f32 v68, v68, s45, -v231
v_fma_f32 v69, v69, s45, -v231
v_fma_f32 v70, v70, s45, -v231
v_mfma_f32_16x16x32_bf16 a[236:239], v[164:167], v[48:51], a[236:239]
ds_read_b64_tr_b16 v[184:185], v220 offset:34816
ds_read_b64_tr_b16 v[186:187], v220 offset:35840
s_waitcnt lgkmcnt(6)
v_fma_f32 v71, v71, s45, -v231
v_exp_f32 v64, v64
v_mfma_f32_16x16x32_bf16 a[240:243], v[168:171], v[48:51], a[240:243]
ds_read_b64_tr_b16 v[188:189], v221 offset:34816
ds_read_b64_tr_b16 v[190:191], v221 offset:35840
v_exp_f32 v65, v65
v_exp_f32 v66, v66
v_mfma_f32_16x16x32_bf16 a[244:247], v[172:175], v[48:51], a[244:247]
v_exp_f32 v67, v67
v_exp_f32 v68, v68
v_mfma_f32_16x16x32_bf16 a[248:251], a[252:255], v[48:51], a[248:251]
ds_read_b64_tr_b16 v[192:193], v222 offset:34816
ds_read_b64_tr_b16 v[194:195], v222 offset:35840
s_waitcnt lgkmcnt(6)
v_exp_f32 v69, v69
v_exp_f32 v70, v70
v_mfma_f32_16x16x32_bf16 a[216:219], v[176:179], v[56:59], a[216:219]
ds_read_b64_tr_b16 v[196:197], v223 offset:34816
ds_read_b64_tr_b16 v[198:199], v223 offset:35840
v_exp_f32 v71, v71
v_cvt_pk_bf16_f32 v64, v64, v65
v_mfma_f32_16x16x32_bf16 a[220:223], v[180:183], v[56:59], a[220:223]
buffer_load_dwordx4 v217, s[16:19], s48 offen offset:3072 lds
ds_read_b64_tr_b16 v[200:201], v224 offset:34816
ds_read_b64_tr_b16 v[202:203], v224 offset:35840
s_waitcnt lgkmcnt(6)
v_cvt_pk_bf16_f32 v65, v66, v67
v_cvt_pk_bf16_f32 v66, v68, v69
v_mfma_f32_16x16x32_bf16 a[224:227], v[184:187], v[56:59], a[224:227]
ds_read_b64_tr_b16 v[204:205], v225 offset:34816
ds_read_b64_tr_b16 v[206:207], v225 offset:35840
v_cvt_pk_bf16_f32 v67, v70, v71
v_fma_f32 v72, v72, s45, -v231
v_fma_f32 v73, v73, s45, -v231
v_mfma_f32_16x16x32_bf16 a[228:231], v[188:191], v[56:59], a[228:231]
s_waitcnt vmcnt(16)
s_barrier
ds_read_b64_tr_b16 v[160:161], v218 offset:49152
ds_read_b64_tr_b16 v[162:163], v218 offset:50176
s_waitcnt lgkmcnt(6)
v_fma_f32 v74, v74, s45, -v231
v_fma_f32 v75, v75, s45, -v231
v_mfma_f32_16x16x32_bf16 a[232:235], v[192:195], v[56:59], a[232:235]
s_add_u32 m0, s37, 131072
s_add_u32 s49, s43, 128
buffer_load_dwordx4 v214, s[16:19], s49 offen lds
ds_read_b64_tr_b16 v[164:165], v219 offset:49152
ds_read_b64_tr_b16 v[166:167], v219 offset:50176
v_fma_f32 v76, v76, s45, -v231
v_fma_f32 v77, v77, s45, -v231
v_mfma_f32_16x16x32_bf16 a[236:239], v[196:199], v[56:59], a[236:239]
ds_read_b64_tr_b16 v[168:169], v220 offset:49152
ds_read_b64_tr_b16 v[170:171], v220 offset:50176
s_waitcnt lgkmcnt(6)
v_fma_f32 v78, v78, s45, -v231
v_fma_f32 v79, v79, s45, -v231
v_mfma_f32_16x16x32_bf16 a[240:243], v[200:203], v[56:59], a[240:243]
ds_read_b64_tr_b16 v[172:173], v221 offset:49152
ds_read_b64_tr_b16 v[174:175], v221 offset:50176
v_exp_f32 v72, v72
v_exp_f32 v73, v73
v_mfma_f32_16x16x32_bf16 a[244:247], v[204:207], v[56:59], a[244:247]
v_exp_f32 v74, v74
v_exp_f32 v75, v75
v_mfma_f32_16x16x32_bf16 a[248:251], a[252:255], v[56:59], a[248:251]
ds_read_b64_tr_b16 v[176:177], v222 offset:49152
ds_read_b64_tr_b16 v[178:179], v222 offset:50176
s_waitcnt lgkmcnt(6)
v_exp_f32 v76, v76
v_exp_f32 v77, v77
v_mfma_f32_16x16x32_bf16 a[216:219], v[160:163], v[64:67], a[216:219]
ds_read_b64_tr_b16 v[180:181], v223 offset:49152
ds_read_b64_tr_b16 v[182:183], v223 offset:50176
v_exp_f32 v78, v78
v_exp_f32 v79, v79
v_cvt_pk_bf16_f32 v72, v72, v73
v_mfma_f32_16x16x32_bf16 a[220:223], v[164:167], v[64:67], a[220:223]
buffer_load_dwordx4 v215, s[16:19], s49 offen offset:1024 lds
ds_read_b64_tr_b16 v[184:185], v224 offset:49152
ds_read_b64_tr_b16 v[186:187], v224 offset:50176
s_waitcnt lgkmcnt(6)
v_cvt_pk_bf16_f32 v73, v74, v75
v_cvt_pk_bf16_f32 v74, v76, v77
v_mfma_f32_16x16x32_bf16 a[224:227], v[168:171], v[64:67], a[224:227]
ds_read_b64_tr_b16 v[188:189], v225 offset:49152
ds_read_b64_tr_b16 v[190:191], v225 offset:50176
v_cvt_pk_bf16_f32 v75, v78, v79
v_fma_f32 v80, v80, s45, -v231
v_mfma_f32_16x16x32_bf16 a[228:231], v[172:175], v[64:67], a[228:231]
ds_read_b64_tr_b16 v[192:193], v218 offset:51200
ds_read_b64_tr_b16 v[194:195], v218 offset:52224
s_waitcnt lgkmcnt(6)
v_fma_f32 v81, v81, s45, -v231
v_fma_f32 v82, v82, s45, -v231
v_mfma_f32_16x16x32_bf16 a[232:235], v[176:179], v[64:67], a[232:235]
buffer_load_dwordx4 v216, s[16:19], s49 offen offset:2048 lds
ds_read_b64_tr_b16 v[196:197], v219 offset:51200
ds_read_b64_tr_b16 v[198:199], v219 offset:52224
v_fma_f32 v83, v83, s45, -v231
v_fma_f32 v84, v84, s45, -v231
v_mfma_f32_16x16x32_bf16 a[236:239], v[180:183], v[64:67], a[236:239]
ds_read_b64_tr_b16 v[200:201], v220 offset:51200
ds_read_b64_tr_b16 v[202:203], v220 offset:52224
s_waitcnt lgkmcnt(6)
v_fma_f32 v85, v85, s45, -v231
v_fma_f32 v86, v86, s45, -v231
v_mfma_f32_16x16x32_bf16 a[240:243], v[184:187], v[64:67], a[240:243]
ds_read_b64_tr_b16 v[204:205], v221 offset:51200
ds_read_b64_tr_b16 v[206:207], v221 offset:52224
v_fma_f32 v87, v87, s45, -v231
v_exp_f32 v80, v80
v_mfma_f32_16x16x32_bf16 a[244:247], v[188:191], v[64:67], a[244:247]
v_exp_f32 v81, v81
v_exp_f32 v82, v82
v_mfma_f32_16x16x32_bf16 a[248:251], a[252:255], v[64:67], a[248:251]
ds_read_b64_tr_b16 v[160:161], v222 offset:51200
ds_read_b64_tr_b16 v[162:163], v222 offset:52224
s_waitcnt lgkmcnt(6)
v_exp_f32 v83, v83
v_exp_f32 v84, v84
v_exp_f32 v85, v85
v_mfma_f32_16x16x32_bf16 a[216:219], v[192:195], v[72:75], a[216:219]
ds_read_b64_tr_b16 v[164:165], v223 offset:51200
ds_read_b64_tr_b16 v[166:167], v223 offset:52224
v_exp_f32 v86, v86
v_exp_f32 v87, v87
v_mfma_f32_16x16x32_bf16 a[220:223], v[196:199], v[72:75], a[220:223]
buffer_load_dwordx4 v217, s[16:19], s49 offen offset:3072 lds
ds_read_b64_tr_b16 v[168:169], v224 offset:51200
ds_read_b64_tr_b16 v[170:171], v224 offset:52224
s_waitcnt lgkmcnt(6)
v_cvt_pk_bf16_f32 v80, v80, v81
v_cvt_pk_bf16_f32 v81, v82, v83
v_mfma_f32_16x16x32_bf16 a[224:227], v[200:203], v[72:75], a[224:227]
ds_read_b64_tr_b16 v[172:173], v225 offset:51200
ds_read_b64_tr_b16 v[174:175], v225 offset:52224
v_cvt_pk_bf16_f32 v82, v84, v85
v_cvt_pk_bf16_f32 v83, v86, v87
v_mfma_f32_16x16x32_bf16 a[228:231], v[204:207], v[72:75], a[228:231]
s_waitcnt vmcnt(16)
s_barrier
v_add_u32 v218, 65536, v227
v_xor_b32 v219, 32, v218
v_xor_b32 v220, 64, v218
v_xor_b32 v221, 96, v218
v_xor_b32 v222, 128, v218
v_xor_b32 v223, 160, v218
v_xor_b32 v224, 192, v218
v_xor_b32 v225, 224, v218
ds_read_b64_tr_b16 v[176:177], v218 offset:0
ds_read_b64_tr_b16 v[178:179], v218 offset:1024
s_waitcnt lgkmcnt(6)
v_fma_f32 v88, v88, s45, -v231
v_fma_f32 v89, v89, s45, -v231
v_mfma_f32_16x16x32_bf16 a[232:235], v[160:163], v[72:75], a[232:235]
s_add_u32 m0, s37, 0
s_add_u32 s48, s43, 256
buffer_load_dwordx4 v214, s[16:19], s48 offen lds
ds_read_b64_tr_b16 v[180:181], v219 offset:0
ds_read_b64_tr_b16 v[182:183], v219 offset:1024
v_fma_f32 v90, v90, s45, -v231
v_fma_f32 v91, v91, s45, -v231
v_mfma_f32_16x16x32_bf16 a[236:239], v[164:167], v[72:75], a[236:239]
ds_read_b64_tr_b16 v[184:185], v220 offset:0
ds_read_b64_tr_b16 v[186:187], v220 offset:1024
s_waitcnt lgkmcnt(6)
v_fma_f32 v92, v92, s45, -v231
v_fma_f32 v93, v93, s45, -v231
v_mfma_f32_16x16x32_bf16 a[240:243], v[168:171], v[72:75], a[240:243]
ds_read_b64_tr_b16 v[188:189], v221 offset:0
ds_read_b64_tr_b16 v[190:191], v221 offset:1024
v_fma_f32 v94, v94, s45, -v231
v_fma_f32 v95, v95, s45, -v231
v_exp_f32 v88, v88
v_mfma_f32_16x16x32_bf16 a[244:247], v[172:175], v[72:75], a[244:247]
v_exp_f32 v89, v89
v_exp_f32 v90, v90
v_mfma_f32_16x16x32_bf16 a[248:251], a[252:255], v[72:75], a[248:251]
ds_read_b64_tr_b16 v[192:193], v222 offset:0
ds_read_b64_tr_b16 v[194:195], v222 offset:1024
s_waitcnt lgkmcnt(6)
v_exp_f32 v91, v91
v_exp_f32 v92, v92
v_mfma_f32_16x16x32_bf16 a[216:219], v[176:179], v[80:83], a[216:219]
ds_read_b64_tr_b16 v[196:197], v223 offset:0
ds_read_b64_tr_b16 v[198:199], v223 offset:1024
v_exp_f32 v93, v93
v_exp_f32 v94, v94
v_mfma_f32_16x16x32_bf16 a[220:223], v[180:183], v[80:83], a[220:223]
buffer_load_dwordx4 v215, s[16:19], s48 offen offset:1024 lds
ds_read_b64_tr_b16 v[200:201], v224 offset:0
ds_read_b64_tr_b16 v[202:203], v224 offset:1024
s_waitcnt lgkmcnt(6)
v_exp_f32 v95, v95
v_cvt_pk_bf16_f32 v88, v88, v89
v_mfma_f32_16x16x32_bf16 a[224:227], v[184:187], v[80:83], a[224:227]
ds_read_b64_tr_b16 v[204:205], v225 offset:0
ds_read_b64_tr_b16 v[206:207], v225 offset:1024
v_cvt_pk_bf16_f32 v89, v90, v91
v_cvt_pk_bf16_f32 v90, v92, v93
v_mfma_f32_16x16x32_bf16 a[228:231], v[188:191], v[80:83], a[228:231]
ds_read_b64_tr_b16 v[160:161], v218 offset:2048
ds_read_b64_tr_b16 v[162:163], v218 offset:3072
s_waitcnt lgkmcnt(6)
v_cvt_pk_bf16_f32 v91, v94, v95
v_fma_f32 v96, v96, s45, -v231
v_mfma_f32_16x16x32_bf16 a[232:235], v[192:195], v[80:83], a[232:235]
buffer_load_dwordx4 v216, s[16:19], s48 offen offset:2048 lds
ds_read_b64_tr_b16 v[164:165], v219 offset:2048
ds_read_b64_tr_b16 v[166:167], v219 offset:3072
v_fma_f32 v97, v97, s45, -v231
v_fma_f32 v98, v98, s45, -v231
v_fma_f32 v99, v99, s45, -v231
v_mfma_f32_16x16x32_bf16 a[236:239], v[196:199], v[80:83], a[236:239]
ds_read_b64_tr_b16 v[168:169], v220 offset:2048
ds_read_b64_tr_b16 v[170:171], v220 offset:3072
s_waitcnt lgkmcnt(6)
v_fma_f32 v100, v100, s45, -v231
v_fma_f32 v101, v101, s45, -v231
v_mfma_f32_16x16x32_bf16 a[240:243], v[200:203], v[80:83], a[240:243]
ds_read_b64_tr_b16 v[172:173], v221 offset:2048
ds_read_b64_tr_b16 v[174:175], v221 offset:3072
v_fma_f32 v102, v102, s45, -v231
v_fma_f32 v103, v103, s45, -v231
v_mfma_f32_16x16x32_bf16 a[244:247], v[204:207], v[80:83], a[244:247]
v_exp_f32 v96, v96
v_exp_f32 v97, v97
v_mfma_f32_16x16x32_bf16 a[248:251], a[252:255], v[80:83], a[248:251]
ds_read_b64_tr_b16 v[176:177], v222 offset:2048
ds_read_b64_tr_b16 v[178:179], v222 offset:3072
s_waitcnt lgkmcnt(6)
v_exp_f32 v98, v98
v_exp_f32 v99, v99
v_mfma_f32_16x16x32_bf16 a[216:219], v[160:163], v[88:91], a[216:219]
ds_read_b64_tr_b16 v[180:181], v223 offset:2048
ds_read_b64_tr_b16 v[182:183], v223 offset:3072
v_exp_f32 v100, v100
v_exp_f32 v101, v101
v_mfma_f32_16x16x32_bf16 a[220:223], v[164:167], v[88:91], a[220:223]
buffer_load_dwordx4 v217, s[16:19], s48 offen offset:3072 lds
ds_read_b64_tr_b16 v[184:185], v224 offset:2048
ds_read_b64_tr_b16 v[186:187], v224 offset:3072
s_waitcnt lgkmcnt(6)
v_exp_f32 v102, v102
v_exp_f32 v103, v103
v_mfma_f32_16x16x32_bf16 a[224:227], v[168:171], v[88:91], a[224:227]
ds_read_b64_tr_b16 v[188:189], v225 offset:2048
ds_read_b64_tr_b16 v[190:191], v225 offset:3072
v_cvt_pk_bf16_f32 v96, v96, v97
v_cvt_pk_bf16_f32 v97, v98, v99
v_cvt_pk_bf16_f32 v98, v100, v101
v_mfma_f32_16x16x32_bf16 a[228:231], v[172:175], v[88:91], a[228:231]
s_waitcnt vmcnt(16)
s_barrier
ds_read_b64_tr_b16 v[192:193], v218 offset:16384
ds_read_b64_tr_b16 v[194:195], v218 offset:17408
s_waitcnt lgkmcnt(6)
v_cvt_pk_bf16_f32 v99, v102, v103
v_fma_f32 v104, v104, s45, -v231
v_mfma_f32_16x16x32_bf16 a[232:235], v[176:179], v[88:91], a[232:235]
s_add_u32 m0, s37, 16384
s_add_u32 s49, s43, 384
buffer_load_dwordx4 v214, s[16:19], s49 offen lds
ds_read_b64_tr_b16 v[196:197], v219 offset:16384
ds_read_b64_tr_b16 v[198:199], v219 offset:17408
v_fma_f32 v105, v105, s45, -v231
v_fma_f32 v106, v106, s45, -v231
v_mfma_f32_16x16x32_bf16 a[236:239], v[180:183], v[88:91], a[236:239]
ds_read_b64_tr_b16 v[200:201], v220 offset:16384
ds_read_b64_tr_b16 v[202:203], v220 offset:17408
s_waitcnt lgkmcnt(6)
v_fma_f32 v107, v107, s45, -v231
v_fma_f32 v108, v108, s45, -v231
v_mfma_f32_16x16x32_bf16 a[240:243], v[184:187], v[88:91], a[240:243]
ds_read_b64_tr_b16 v[204:205], v221 offset:16384
ds_read_b64_tr_b16 v[206:207], v221 offset:17408
v_fma_f32 v109, v109, s45, -v231
v_fma_f32 v110, v110, s45, -v231
v_mfma_f32_16x16x32_bf16 a[244:247], v[188:191], v[88:91], a[244:247]
v_fma_f32 v111, v111, s45, -v231
v_exp_f32 v104, v104
v_mfma_f32_16x16x32_bf16 a[248:251], a[252:255], v[88:91], a[248:251]
ds_read_b64_tr_b16 v[160:161], v222 offset:16384
ds_read_b64_tr_b16 v[162:163], v222 offset:17408
s_waitcnt lgkmcnt(6)
v_exp_f32 v105, v105
v_exp_f32 v106, v106
v_mfma_f32_16x16x32_bf16 a[216:219], v[192:195], v[96:99], a[216:219]
ds_read_b64_tr_b16 v[164:165], v223 offset:16384
ds_read_b64_tr_b16 v[166:167], v223 offset:17408
v_exp_f32 v107, v107
v_exp_f32 v108, v108
v_mfma_f32_16x16x32_bf16 a[220:223], v[196:199], v[96:99], a[220:223]
buffer_load_dwordx4 v215, s[16:19], s49 offen offset:1024 lds
ds_read_b64_tr_b16 v[168:169], v224 offset:16384
ds_read_b64_tr_b16 v[170:171], v224 offset:17408
s_waitcnt lgkmcnt(6)
v_exp_f32 v109, v109
v_exp_f32 v110, v110
v_exp_f32 v111, v111
v_mfma_f32_16x16x32_bf16 a[224:227], v[200:203], v[96:99], a[224:227]
ds_read_b64_tr_b16 v[172:173], v225 offset:16384
ds_read_b64_tr_b16 v[174:175], v225 offset:17408
v_cvt_pk_bf16_f32 v104, v104, v105
v_cvt_pk_bf16_f32 v105, v106, v107
v_mfma_f32_16x16x32_bf16 a[228:231], v[204:207], v[96:99], a[228:231]
ds_read_b64_tr_b16 v[176:177], v218 offset:18432
ds_read_b64_tr_b16 v[178:179], v218 offset:19456
s_waitcnt lgkmcnt(6)
v_cvt_pk_bf16_f32 v106, v108, v109
v_cvt_pk_bf16_f32 v107, v110, v111
v_mfma_f32_16x16x32_bf16 a[232:235], v[160:163], v[96:99], a[232:235]
buffer_load_dwordx4 v216, s[16:19], s49 offen offset:2048 lds
ds_read_b64_tr_b16 v[180:181], v219 offset:18432
ds_read_b64_tr_b16 v[182:183], v219 offset:19456
v_fma_f32 v112, v112, s45, -v231
v_fma_f32 v113, v113, s45, -v231
v_mfma_f32_16x16x32_bf16 a[236:239], v[164:167], v[96:99], a[236:239]
ds_read_b64_tr_b16 v[184:185], v220 offset:18432
ds_read_b64_tr_b16 v[186:187], v220 offset:19456
s_waitcnt lgkmcnt(6)
v_fma_f32 v114, v114, s45, -v231
v_fma_f32 v115, v115, s45, -v231
v_mfma_f32_16x16x32_bf16 a[240:243], v[168:171], v[96:99], a[240:243]
ds_read_b64_tr_b16 v[188:189], v221 offset:18432
ds_read_b64_tr_b16 v[190:191], v221 offset:19456
v_fma_f32 v116, v116, s45, -v231
v_fma_f32 v117, v117, s45, -v231
v_mfma_f32_16x16x32_bf16 a[244:247], v[172:175], v[96:99], a[244:247]
v_fma_f32 v118, v118, s45, -v231
v_fma_f32 v119, v119, s45, -v231
v_mfma_f32_16x16x32_bf16 a[248:251], a[252:255], v[96:99], a[248:251]
ds_read_b64_tr_b16 v[192:193], v222 offset:18432
ds_read_b64_tr_b16 v[194:195], v222 offset:19456
s_waitcnt lgkmcnt(6)
v_exp_f32 v112, v112
v_exp_f32 v113, v113
v_exp_f32 v114, v114
v_mfma_f32_16x16x32_bf16 a[216:219], v[176:179], v[104:107], a[216:219]
ds_read_b64_tr_b16 v[196:197], v223 offset:18432
ds_read_b64_tr_b16 v[198:199], v223 offset:19456
v_exp_f32 v115, v115
v_exp_f32 v116, v116
v_mfma_f32_16x16x32_bf16 a[220:223], v[180:183], v[104:107], a[220:223]
buffer_load_dwordx4 v217, s[16:19], s49 offen offset:3072 lds
ds_read_b64_tr_b16 v[200:201], v224 offset:18432
ds_read_b64_tr_b16 v[202:203], v224 offset:19456
s_waitcnt lgkmcnt(6)
v_exp_f32 v117, v117
v_exp_f32 v118, v118
v_mfma_f32_16x16x32_bf16 a[224:227], v[184:187], v[104:107], a[224:227]
ds_read_b64_tr_b16 v[204:205], v225 offset:18432
ds_read_b64_tr_b16 v[206:207], v225 offset:19456
v_exp_f32 v119, v119
v_cvt_pk_bf16_f32 v112, v112, v113
v_mfma_f32_16x16x32_bf16 a[228:231], v[188:191], v[104:107], a[228:231]
s_waitcnt vmcnt(16)
s_barrier
ds_read_b64_tr_b16 v[160:161], v218 offset:32768
ds_read_b64_tr_b16 v[162:163], v218 offset:33792
s_waitcnt lgkmcnt(6)
v_cvt_pk_bf16_f32 v113, v114, v115
v_cvt_pk_bf16_f32 v114, v116, v117
v_mfma_f32_16x16x32_bf16 a[232:235], v[192:195], v[104:107], a[232:235]
s_add_u32 m0, s37, 32768
s_add_u32 s48, s43, 512
buffer_load_dwordx4 v214, s[16:19], s48 offen lds
ds_read_b64_tr_b16 v[164:165], v219 offset:32768
ds_read_b64_tr_b16 v[166:167], v219 offset:33792
v_cvt_pk_bf16_f32 v115, v118, v119
v_fma_f32 v120, v120, s45, -v231
v_mfma_f32_16x16x32_bf16 a[236:239], v[196:199], v[104:107], a[236:239]
ds_read_b64_tr_b16 v[168:169], v220 offset:32768
ds_read_b64_tr_b16 v[170:171], v220 offset:33792
s_waitcnt lgkmcnt(6)
v_fma_f32 v121, v121, s45, -v231
v_fma_f32 v122, v122, s45, -v231
v_mfma_f32_16x16x32_bf16 a[240:243], v[200:203], v[104:107], a[240:243]
ds_read_b64_tr_b16 v[172:173], v221 offset:32768
ds_read_b64_tr_b16 v[174:175], v221 offset:33792
v_fma_f32 v123, v123, s45, -v231
v_fma_f32 v124, v124, s45, -v231
v_fma_f32 v125, v125, s45, -v231
v_mfma_f32_16x16x32_bf16 a[244:247], v[204:207], v[104:107], a[244:247]
v_fma_f32 v126, v126, s45, -v231
v_fma_f32 v127, v127, s45, -v231
v_mfma_f32_16x16x32_bf16 a[248:251], a[252:255], v[104:107], a[248:251]
ds_read_b64_tr_b16 v[176:177], v222 offset:32768
ds_read_b64_tr_b16 v[178:179], v222 offset:33792
s_waitcnt lgkmcnt(6)
v_exp_f32 v120, v120
v_exp_f32 v121, v121
v_mfma_f32_16x16x32_bf16 a[216:219], v[160:163], v[112:115], a[216:219]
ds_read_b64_tr_b16 v[180:181], v223 offset:32768
ds_read_b64_tr_b16 v[182:183], v223 offset:33792
v_exp_f32 v122, v122
v_exp_f32 v123, v123
v_mfma_f32_16x16x32_bf16 a[220:223], v[164:167], v[112:115], a[220:223]
buffer_load_dwordx4 v215, s[16:19], s48 offen offset:1024 lds
ds_read_b64_tr_b16 v[184:185], v224 offset:32768
ds_read_b64_tr_b16 v[186:187], v224 offset:33792
s_waitcnt lgkmcnt(6)
v_exp_f32 v124, v124
v_exp_f32 v125, v125
v_mfma_f32_16x16x32_bf16 a[224:227], v[168:171], v[112:115], a[224:227]
ds_read_b64_tr_b16 v[188:189], v225 offset:32768
ds_read_b64_tr_b16 v[190:191], v225 offset:33792
v_exp_f32 v126, v126
v_exp_f32 v127, v127
v_mfma_f32_16x16x32_bf16 a[228:231], v[172:175], v[112:115], a[228:231]
ds_read_b64_tr_b16 v[192:193], v218 offset:34816
ds_read_b64_tr_b16 v[194:195], v218 offset:35840
s_waitcnt lgkmcnt(6)
v_cvt_pk_bf16_f32 v120, v120, v121
v_cvt_pk_bf16_f32 v121, v122, v123
v_mfma_f32_16x16x32_bf16 a[232:235], v[176:179], v[112:115], a[232:235]
buffer_load_dwordx4 v216, s[16:19], s48 offen offset:2048 lds
ds_read_b64_tr_b16 v[196:197], v219 offset:34816
ds_read_b64_tr_b16 v[198:199], v219 offset:35840
v_cvt_pk_bf16_f32 v122, v124, v125
v_cvt_pk_bf16_f32 v123, v126, v127
v_mfma_f32_16x16x32_bf16 a[236:239], v[180:183], v[112:115], a[236:239]
ds_read_b64_tr_b16 v[200:201], v220 offset:34816
ds_read_b64_tr_b16 v[202:203], v220 offset:35840
s_waitcnt lgkmcnt(6)
v_mfma_f32_16x16x32_bf16 a[240:243], v[184:187], v[112:115], a[240:243]
ds_read_b64_tr_b16 v[204:205], v221 offset:34816
ds_read_b64_tr_b16 v[206:207], v221 offset:35840
v_mfma_f32_16x16x32_bf16 a[244:247], v[188:191], v[112:115], a[244:247]
v_mfma_f32_16x16x32_bf16 a[248:251], a[252:255], v[112:115], a[248:251]
ds_read_b64_tr_b16 v[160:161], v222 offset:34816
ds_read_b64_tr_b16 v[162:163], v222 offset:35840
s_waitcnt lgkmcnt(6)
v_mfma_f32_16x16x32_bf16 a[216:219], v[192:195], v[120:123], a[216:219]
ds_read_b64_tr_b16 v[164:165], v223 offset:34816
ds_read_b64_tr_b16 v[166:167], v223 offset:35840
v_mfma_f32_16x16x32_bf16 a[220:223], v[196:199], v[120:123], a[220:223]
buffer_load_dwordx4 v217, s[16:19], s48 offen offset:3072 lds
ds_read_b64_tr_b16 v[168:169], v224 offset:34816
ds_read_b64_tr_b16 v[170:171], v224 offset:35840
s_waitcnt lgkmcnt(6)
v_mfma_f32_16x16x32_bf16 a[224:227], v[200:203], v[120:123], a[224:227]
ds_read_b64_tr_b16 v[172:173], v225 offset:34816
ds_read_b64_tr_b16 v[174:175], v225 offset:35840
v_mfma_f32_16x16x32_bf16 a[228:231], v[204:207], v[120:123], a[228:231]
s_waitcnt lgkmcnt(4)
v_mfma_f32_16x16x32_bf16 a[232:235], v[160:163], v[120:123], a[232:235]
v_mfma_f32_16x16x32_bf16 a[236:239], v[164:167], v[120:123], a[236:239]
s_waitcnt lgkmcnt(0)
v_mfma_f32_16x16x32_bf16 a[240:243], v[168:171], v[120:123], a[240:243]
v_mfma_f32_16x16x32_bf16 a[244:247], v[172:175], v[120:123], a[244:247]
v_mfma_f32_16x16x32_bf16 a[248:251], a[252:255], v[120:123], a[248:251]
s_nop 7
v_accvgpr_read_b32 v64, a248
v_add_u32 v232, 147456, v241
v_rcp_f32 v64, v64
v_accvgpr_read_b32 v72, a216
v_accvgpr_read_b32 v73, a217
v_accvgpr_read_b32 v74, a218
v_accvgpr_read_b32 v75, a219
v_accvgpr_read_b32 v76, a220
v_accvgpr_read_b32 v77, a221
v_accvgpr_read_b32 v78, a222
v_accvgpr_read_b32 v79, a223
v_mul_f32 v72, v72, v64
v_mul_f32 v73, v73, v64
v_mul_f32 v74, v74, v64
v_mul_f32 v75, v75, v64
v_mul_f32 v76, v76, v64
v_mul_f32 v77, v77, v64
v_mul_f32 v78, v78, v64
v_mul_f32 v79, v79, v64
v_cvt_pk_bf16_f32 v80, v72, v73
v_cvt_pk_bf16_f32 v81, v74, v75
v_cvt_pk_bf16_f32 v82, v76, v77
v_cvt_pk_bf16_f32 v83, v78, v79
ds_write_b128 v232, v[80:83] offset:0
v_accvgpr_read_b32 v84, a224
v_accvgpr_read_b32 v85, a225
v_accvgpr_read_b32 v86, a226
v_accvgpr_read_b32 v87, a227
v_accvgpr_read_b32 v88, a228
v_accvgpr_read_b32 v89, a229
v_accvgpr_read_b32 v90, a230
v_accvgpr_read_b32 v91, a231
v_mul_f32 v84, v84, v64
v_mul_f32 v85, v85, v64
v_mul_f32 v86, v86, v64
v_mul_f32 v87, v87, v64
v_mul_f32 v88, v88, v64
v_mul_f32 v89, v89, v64
v_mul_f32 v90, v90, v64
v_mul_f32 v91, v91, v64
v_cvt_pk_bf16_f32 v92, v84, v85
v_cvt_pk_bf16_f32 v93, v86, v87
v_cvt_pk_bf16_f32 v94, v88, v89
v_cvt_pk_bf16_f32 v95, v90, v91
ds_write_b128 v232, v[92:95] offset:4096
v_accvgpr_read_b32 v96, a232
v_accvgpr_read_b32 v97, a233
v_accvgpr_read_b32 v98, a234
v_accvgpr_read_b32 v99, a235
v_accvgpr_read_b32 v100, a236
v_accvgpr_read_b32 v101, a237
v_accvgpr_read_b32 v102, a238
v_accvgpr_read_b32 v103, a239
v_mul_f32 v96, v96, v64
v_mul_f32 v97, v97, v64
v_mul_f32 v98, v98, v64
v_mul_f32 v99, v99, v64
v_mul_f32 v100, v100, v64
v_mul_f32 v101, v101, v64
v_mul_f32 v102, v102, v64
v_mul_f32 v103, v103, v64
v_cvt_pk_bf16_f32 v104, v96, v97
v_cvt_pk_bf16_f32 v105, v98, v99
v_cvt_pk_bf16_f32 v106, v100, v101
v_cvt_pk_bf16_f32 v107, v102, v103
ds_write_b128 v232, v[104:107] offset:8192
v_accvgpr_read_b32 v108, a240
v_accvgpr_read_b32 v109, a241
v_accvgpr_read_b32 v110, a242
v_accvgpr_read_b32 v111, a243
v_accvgpr_read_b32 v112, a244
v_accvgpr_read_b32 v113, a245
v_accvgpr_read_b32 v114, a246
v_accvgpr_read_b32 v115, a247
v_mul_f32 v108, v108, v64
v_mul_f32 v109, v109, v64
v_mul_f32 v110, v110, v64
v_mul_f32 v111, v111, v64
v_mul_f32 v112, v112, v64
v_mul_f32 v113, v113, v64
v_mul_f32 v114, v114, v64
v_mul_f32 v115, v115, v64
v_cvt_pk_bf16_f32 v116, v108, v109
v_cvt_pk_bf16_f32 v117, v110, v111
v_cvt_pk_bf16_f32 v118, v112, v113
v_cvt_pk_bf16_f32 v119, v114, v115
ds_write_b128 v232, v[116:119] offset:12288
s_cmp_eq_u32 s44, 3
s_cbranch_scc1 L_Olast
s_waitcnt lgkmcnt(0)
s_waitcnt vmcnt(16)
s_barrier
v_add_u32 v232, 147456, v240
ds_read_b128 v[0:3], v232 offset:0
ds_read_b128 v[4:7], v232 offset:1024
ds_read_b128 v[8:11], v232 offset:2048
ds_read_b128 v[12:15], v232 offset:3072
ds_read_b128 v[16:19], v232 offset:4096
ds_read_b128 v[20:23], v232 offset:5120
ds_read_b128 v[24:27], v232 offset:6144
ds_read_b128 v[28:31], v232 offset:7168
ds_read_b128 v[32:35], v232 offset:8192
ds_read_b128 v[36:39], v232 offset:9216
ds_read_b128 v[40:43], v232 offset:10240
ds_read_b128 v[44:47], v232 offset:11264
ds_read_b128 v[48:51], v232 offset:12288
ds_read_b128 v[52:55], v232 offset:13312
ds_read_b128 v[56:59], v232 offset:14336
ds_read_b128 v[60:63], v232 offset:15360
v_add_u32 v242, 65536, v229
ds_read_b64_tr_b16 v[176:177], v242 offset:49152
ds_read_b64_tr_b16 v[178:179], v242 offset:51200
s_waitcnt lgkmcnt(2)
s_waitcnt lgkmcnt(0)
v_mfma_f32_16x16x32_bf16 a[0:3], v[176:179], v[0:3], a[0:3]
ds_read_b64_tr_b16 v[180:181], v242 offset:53248
v_mfma_f32_16x16x32_bf16 a[4:7], v[176:179], v[4:7], a[4:7]
s_add_u32 m0, s37, 49152
s_add_u32 s49, s43, 640
buffer_load_dwordx4 v214, s[16:19], s49 offen lds
ds_read_b64_tr_b16 v[182:183], v242 offset:55296
v_mfma_f32_16x16x32_bf16 a[8:11], v[176:179], v[8:11], a[8:11]
ds_read_b64_tr_b16 v[184:185], v242 offset:57344
v_mfma_f32_16x16x32_bf16 a[12:15], v[176:179], v[12:15], a[12:15]
ds_read_b64_tr_b16 v[186:187], v242 offset:59392
s_waitcnt lgkmcnt(0)
v_mfma_f32_16x16x32_bf16 a[0:3], v[180:183], v[16:19], a[0:3]
ds_read_b64_tr_b16 v[188:189], v242 offset:61440
v_mfma_f32_16x16x32_bf16 a[4:7], v[180:183], v[20:23], a[4:7]
buffer_load_dwordx4 v215, s[16:19], s49 offen offset:1024 lds
ds_read_b64_tr_b16 v[190:191], v242 offset:63488
v_mfma_f32_16x16x32_bf16 a[8:11], v[180:183], v[24:27], a[8:11]
v_mfma_f32_16x16x32_bf16 a[12:15], v[180:183], v[28:31], a[12:15]
buffer_load_dwordx4 v216, s[16:19], s49 offen offset:2048 lds
buffer_load_dwordx4 v217, s[16:19], s49 offen offset:3072 lds
s_waitcnt vmcnt(16)
s_barrier
v_add_u32 v242, 131072, v229
ds_read_b64_tr_b16 v[192:193], v242 offset:0
v_mfma_f32_16x16x32_bf16 a[0:3], v[184:187], v[32:35], a[0:3]
ds_read_b64_tr_b16 v[194:195], v242 offset:2048
v_mfma_f32_16x16x32_bf16 a[4:7], v[184:187], v[36:39], a[4:7]
s_add_u32 m0, s37, 65536
s_add_u32 s48, s43, 768
buffer_load_dwordx4 v214, s[16:19], s48 offen lds
v_mfma_f32_16x16x32_bf16 a[8:11], v[184:187], v[40:43], a[8:11]
v_mfma_f32_16x16x32_bf16 a[12:15], v[184:187], v[44:47], a[12:15]
ds_read_b64_tr_b16 v[196:197], v242 offset:4096
s_waitcnt lgkmcnt(1)
v_mfma_f32_16x16x32_bf16 a[0:3], v[188:191], v[48:51], a[0:3]
ds_read_b64_tr_b16 v[198:199], v242 offset:6144
v_mfma_f32_16x16x32_bf16 a[4:7], v[188:191], v[52:55], a[4:7]
buffer_load_dwordx4 v215, s[16:19], s48 offen offset:1024 lds
v_mfma_f32_16x16x32_bf16 a[8:11], v[188:191], v[56:59], a[8:11]
v_mfma_f32_16x16x32_bf16 a[12:15], v[188:191], v[60:63], a[12:15]
ds_read_b64_tr_b16 v[200:201], v242 offset:8192
v_mfma_f32_16x16x32_bf16 a[16:19], v[192:195], v[0:3], a[16:19]
ds_read_b64_tr_b16 v[202:203], v242 offset:10240
v_mfma_f32_16x16x32_bf16 a[20:23], v[192:195], v[4:7], a[20:23]
buffer_load_dwordx4 v216, s[16:19], s48 offen offset:2048 lds
v_mfma_f32_16x16x32_bf16 a[24:27], v[192:195], v[8:11], a[24:27]
v_mfma_f32_16x16x32_bf16 a[28:31], v[192:195], v[12:15], a[28:31]
ds_read_b64_tr_b16 v[204:205], v242 offset:12288
s_waitcnt lgkmcnt(1)
v_mfma_f32_16x16x32_bf16 a[16:19], v[196:199], v[16:19], a[16:19]
ds_read_b64_tr_b16 v[206:207], v242 offset:14336
v_mfma_f32_16x16x32_bf16 a[20:23], v[196:199], v[20:23], a[20:23]
buffer_load_dwordx4 v217, s[16:19], s48 offen offset:3072 lds
v_mfma_f32_16x16x32_bf16 a[24:27], v[196:199], v[24:27], a[24:27]
v_mfma_f32_16x16x32_bf16 a[28:31], v[196:199], v[28:31], a[28:31]
s_waitcnt vmcnt(16)
s_barrier
v_mov_b32 v242, v229
ds_read_b64_tr_b16 v[160:161], v242 offset:0
v_mfma_f32_16x16x32_bf16 a[16:19], v[200:203], v[32:35], a[16:19]
ds_read_b64_tr_b16 v[162:163], v242 offset:2048
v_mfma_f32_16x16x32_bf16 a[20:23], v[200:203], v[36:39], a[20:23]
s_add_u32 m0, s37, 81920
s_add_u32 s49, s43, 896
buffer_load_dwordx4 v214, s[16:19], s49 offen lds
v_mfma_f32_16x16x32_bf16 a[24:27], v[200:203], v[40:43], a[24:27]
v_mfma_f32_16x16x32_bf16 a[28:31], v[200:203], v[44:47], a[28:31]
ds_read_b64_tr_b16 v[164:165], v242 offset:4096
s_waitcnt lgkmcnt(1)
v_mfma_f32_16x16x32_bf16 a[16:19], v[204:207], v[48:51], a[16:19]
ds_read_b64_tr_b16 v[166:167], v242 offset:6144
v_mfma_f32_16x16x32_bf16 a[20:23], v[204:207], v[52:55], a[20:23]
buffer_load_dwordx4 v215, s[16:19], s49 offen offset:1024 lds
v_mfma_f32_16x16x32_bf16 a[24:27], v[204:207], v[56:59], a[24:27]
v_mfma_f32_16x16x32_bf16 a[28:31], v[204:207], v[60:63], a[28:31]
ds_read_b64_tr_b16 v[168:169], v242 offset:8192
v_mfma_f32_16x16x32_bf16 a[32:35], v[160:163], v[0:3], a[32:35]
ds_read_b64_tr_b16 v[170:171], v242 offset:10240
v_mfma_f32_16x16x32_bf16 a[36:39], v[160:163], v[4:7], a[36:39]
buffer_load_dwordx4 v216, s[16:19], s49 offen offset:2048 lds
v_mfma_f32_16x16x32_bf16 a[40:43], v[160:163], v[8:11], a[40:43]
v_mfma_f32_16x16x32_bf16 a[44:47], v[160:163], v[12:15], a[44:47]
ds_read_b64_tr_b16 v[172:173], v242 offset:12288
s_waitcnt lgkmcnt(1)
v_mfma_f32_16x16x32_bf16 a[32:35], v[164:167], v[16:19], a[32:35]
ds_read_b64_tr_b16 v[174:175], v242 offset:14336
v_mfma_f32_16x16x32_bf16 a[36:39], v[164:167], v[20:23], a[36:39]
buffer_load_dwordx4 v217, s[16:19], s49 offen offset:3072 lds
v_mfma_f32_16x16x32_bf16 a[40:43], v[164:167], v[24:27], a[40:43]
v_mfma_f32_16x16x32_bf16 a[44:47], v[164:167], v[28:31], a[44:47]
s_waitcnt vmcnt(16)
s_barrier
ds_read_b64_tr_b16 v[176:177], v242 offset:16384
v_mfma_f32_16x16x32_bf16 a[32:35], v[168:171], v[32:35], a[32:35]
ds_read_b64_tr_b16 v[178:179], v242 offset:18432
v_mfma_f32_16x16x32_bf16 a[36:39], v[168:171], v[36:39], a[36:39]
s_add_u32 m0, s37, 98304
s_add_u32 s48, s43, 1024
buffer_load_dwordx4 v214, s[16:19], s48 offen lds
v_mfma_f32_16x16x32_bf16 a[40:43], v[168:171], v[40:43], a[40:43]
v_mfma_f32_16x16x32_bf16 a[44:47], v[168:171], v[44:47], a[44:47]
ds_read_b64_tr_b16 v[180:181], v242 offset:20480
s_waitcnt lgkmcnt(1)
v_mfma_f32_16x16x32_bf16 a[32:35], v[172:175], v[48:51], a[32:35]
ds_read_b64_tr_b16 v[182:183], v242 offset:22528
v_mfma_f32_16x16x32_bf16 a[36:39], v[172:175], v[52:55], a[36:39]
buffer_load_dwordx4 v215, s[16:19], s48 offen offset:1024 lds
v_mfma_f32_16x16x32_bf16 a[40:43], v[172:175], v[56:59], a[40:43]
v_mfma_f32_16x16x32_bf16 a[44:47], v[172:175], v[60:63], a[44:47]
ds_read_b64_tr_b16 v[184:185], v242 offset:24576
v_mfma_f32_16x16x32_bf16 a[48:51], v[176:179], v[0:3], a[48:51]
ds_read_b64_tr_b16 v[186:187], v242 offset:26624
v_mfma_f32_16x16x32_bf16 a[52:55], v[176:179], v[4:7], a[52:55]
buffer_load_dwordx4 v216, s[16:19], s48 offen offset:2048 lds
v_mfma_f32_16x16x32_bf16 a[56:59], v[176:179], v[8:11], a[56:59]
v_mfma_f32_16x16x32_bf16 a[60:63], v[176:179], v[12:15], a[60:63]
ds_read_b64_tr_b16 v[188:189], v242 offset:28672
s_waitcnt lgkmcnt(1)
v_mfma_f32_16x16x32_bf16 a[48:51], v[180:183], v[16:19], a[48:51]
ds_read_b64_tr_b16 v[190:191], v242 offset:30720
v_mfma_f32_16x16x32_bf16 a[52:55], v[180:183], v[20:23], a[52:55]
buffer_load_dwordx4 v217, s[16:19], s48 offen offset:3072 lds
v_mfma_f32_16x16x32_bf16 a[56:59], v[180:183], v[24:27], a[56:59]
v_mfma_f32_16x16x32_bf16 a[60:63], v[180:183], v[28:31], a[60:63]
s_waitcnt vmcnt(16)
s_barrier
ds_read_b64_tr_b16 v[192:193], v242 offset:32768
v_mfma_f32_16x16x32_bf16 a[48:51], v[184:187], v[32:35], a[48:51]
ds_read_b64_tr_b16 v[194:195], v242 offset:34816
v_mfma_f32_16x16x32_bf16 a[52:55], v[184:187], v[36:39], a[52:55]
s_add_u32 m0, s37, 114688
s_add_u32 s49, s42, 0
buffer_load_dwordx4 v210, s[12:15], s49 offen lds
v_mfma_f32_16x16x32_bf16 a[56:59], v[184:187], v[40:43], a[56:59]
v_mfma_f32_16x16x32_bf16 a[60:63], v[184:187], v[44:47], a[60:63]
ds_read_b64_tr_b16 v[196:197], v242 offset:36864
s_waitcnt lgkmcnt(1)
v_mfma_f32_16x16x32_bf16 a[48:51], v[188:191], v[48:51], a[48:51]
ds_read_b64_tr_b16 v[198:199], v242 offset:38912
v_mfma_f32_16x16x32_bf16 a[52:55], v[188:191], v[52:55], a[52:55]
buffer_load_dwordx4 v211, s[12:15], s49 offen offset:1024 lds
v_mfma_f32_16x16x32_bf16 a[56:59], v[188:191], v[56:59], a[56:59]
v_mfma_f32_16x16x32_bf16 a[60:63], v[188:191], v[60:63], a[60:63]
ds_read_b64_tr_b16 v[200:201], v242 offset:40960
v_mfma_f32_16x16x32_bf16 a[64:67], v[192:195], v[0:3], a[64:67]
ds_read_b64_tr_b16 v[202:203], v242 offset:43008
v_mfma_f32_16x16x32_bf16 a[68:71], v[192:195], v[4:7], a[68:71]
buffer_load_dwordx4 v212, s[12:15], s49 offen offset:2048 lds
v_mfma_f32_16x16x32_bf16 a[72:75], v[192:195], v[8:11], a[72:75]
v_mfma_f32_16x16x32_bf16 a[76:79], v[192:195], v[12:15], a[76:79]
ds_read_b64_tr_b16 v[204:205], v242 offset:45056
s_waitcnt lgkmcnt(1)
v_mfma_f32_16x16x32_bf16 a[64:67], v[196:199], v[16:19], a[64:67]
ds_read_b64_tr_b16 v[206:207], v242 offset:47104
v_mfma_f32_16x16x32_bf16 a[68:71], v[196:199], v[20:23], a[68:71]
buffer_load_dwordx4 v213, s[12:15], s49 offen offset:3072 lds
v_mfma_f32_16x16x32_bf16 a[72:75], v[196:199], v[24:27], a[72:75]
v_mfma_f32_16x16x32_bf16 a[76:79], v[196:199], v[28:31], a[76:79]
s_waitcnt vmcnt(16)
s_barrier
ds_read_b64_tr_b16 v[160:161], v242 offset:49152
v_mfma_f32_16x16x32_bf16 a[64:67], v[200:203], v[32:35], a[64:67]
ds_read_b64_tr_b16 v[162:163], v242 offset:51200
v_mfma_f32_16x16x32_bf16 a[68:71], v[200:203], v[36:39], a[68:71]
s_add_u32 m0, s37, 131072
s_add_u32 s48, s42, 524288
buffer_load_dwordx4 v210, s[12:15], s48 offen lds
v_mfma_f32_16x16x32_bf16 a[72:75], v[200:203], v[40:43], a[72:75]
v_mfma_f32_16x16x32_bf16 a[76:79], v[200:203], v[44:47], a[76:79]
ds_read_b64_tr_b16 v[164:165], v242 offset:53248
s_waitcnt lgkmcnt(1)
v_mfma_f32_16x16x32_bf16 a[64:67], v[204:207], v[48:51], a[64:67]
ds_read_b64_tr_b16 v[166:167], v242 offset:55296
v_mfma_f32_16x16x32_bf16 a[68:71], v[204:207], v[52:55], a[68:71]
buffer_load_dwordx4 v211, s[12:15], s48 offen offset:1024 lds
v_mfma_f32_16x16x32_bf16 a[72:75], v[204:207], v[56:59], a[72:75]
v_mfma_f32_16x16x32_bf16 a[76:79], v[204:207], v[60:63], a[76:79]
ds_read_b64_tr_b16 v[168:169], v242 offset:57344
v_mfma_f32_16x16x32_bf16 a[80:83], v[160:163], v[0:3], a[80:83]
ds_read_b64_tr_b16 v[170:171], v242 offset:59392
v_mfma_f32_16x16x32_bf16 a[84:87], v[160:163], v[4:7], a[84:87]
buffer_load_dwordx4 v212, s[12:15], s48 offen offset:2048 lds
v_mfma_f32_16x16x32_bf16 a[88:91], v[160:163], v[8:11], a[88:91]
v_mfma_f32_16x16x32_bf16 a[92:95], v[160:163], v[12:15], a[92:95]
ds_read_b64_tr_b16 v[172:173], v242 offset:61440
s_waitcnt lgkmcnt(1)
v_mfma_f32_16x16x32_bf16 a[80:83], v[164:167], v[16:19], a[80:83]
ds_read_b64_tr_b16 v[174:175], v242 offset:63488
v_mfma_f32_16x16x32_bf16 a[84:87], v[164:167], v[20:23], a[84:87]
buffer_load_dwordx4 v213, s[12:15], s48 offen offset:3072 lds
v_mfma_f32_16x16x32_bf16 a[88:91], v[164:167], v[24:27], a[88:91]
v_mfma_f32_16x16x32_bf16 a[92:95], v[164:167], v[28:31], a[92:95]
s_waitcnt vmcnt(16)
s_barrier
v_add_u32 v242, 65536, v229
ds_read_b64_tr_b16 v[176:177], v242 offset:0
v_mfma_f32_16x16x32_bf16 a[80:83], v[168:171], v[32:35], a[80:83]
ds_read_b64_tr_b16 v[178:179], v242 offset:2048
v_mfma_f32_16x16x32_bf16 a[84:87], v[168:171], v[36:39], a[84:87]
s_add_u32 m0, s37, 0
s_add_u32 s49, s42, 1048576
buffer_load_dwordx4 v210, s[12:15], s49 offen lds
v_mfma_f32_16x16x32_bf16 a[88:91], v[168:171], v[40:43], a[88:91]
v_mfma_f32_16x16x32_bf16 a[92:95], v[168:171], v[44:47], a[92:95]
ds_read_b64_tr_b16 v[180:181], v242 offset:4096
s_waitcnt lgkmcnt(1)
v_mfma_f32_16x16x32_bf16 a[80:83], v[172:175], v[48:51], a[80:83]
ds_read_b64_tr_b16 v[182:183], v242 offset:6144
v_mfma_f32_16x16x32_bf16 a[84:87], v[172:175], v[52:55], a[84:87]
buffer_load_dwordx4 v211, s[12:15], s49 offen offset:1024 lds
v_mfma_f32_16x16x32_bf16 a[88:91], v[172:175], v[56:59], a[88:91]
v_mfma_f32_16x16x32_bf16 a[92:95], v[172:175], v[60:63], a[92:95]
ds_read_b64_tr_b16 v[184:185], v242 offset:8192
v_mfma_f32_16x16x32_bf16 a[96:99], v[176:179], v[0:3], a[96:99]
ds_read_b64_tr_b16 v[186:187], v242 offset:10240
v_mfma_f32_16x16x32_bf16 a[100:103], v[176:179], v[4:7], a[100:103]
buffer_load_dwordx4 v212, s[12:15], s49 offen offset:2048 lds
v_mfma_f32_16x16x32_bf16 a[104:107], v[176:179], v[8:11], a[104:107]
v_mfma_f32_16x16x32_bf16 a[108:111], v[176:179], v[12:15], a[108:111]
ds_read_b64_tr_b16 v[188:189], v242 offset:12288
s_waitcnt lgkmcnt(1)
v_mfma_f32_16x16x32_bf16 a[96:99], v[180:183], v[16:19], a[96:99]
ds_read_b64_tr_b16 v[190:191], v242 offset:14336
v_mfma_f32_16x16x32_bf16 a[100:103], v[180:183], v[20:23], a[100:103]
buffer_load_dwordx4 v213, s[12:15], s49 offen offset:3072 lds
v_mfma_f32_16x16x32_bf16 a[104:107], v[180:183], v[24:27], a[104:107]
v_mfma_f32_16x16x32_bf16 a[108:111], v[180:183], v[28:31], a[108:111]
s_waitcnt vmcnt(16)
s_barrier
ds_read_b64_tr_b16 v[192:193], v242 offset:16384
v_mfma_f32_16x16x32_bf16 a[96:99], v[184:187], v[32:35], a[96:99]
ds_read_b64_tr_b16 v[194:195], v242 offset:18432
v_mfma_f32_16x16x32_bf16 a[100:103], v[184:187], v[36:39], a[100:103]
s_add_u32 m0, s37, 16384
s_add_u32 s48, s42, 1572864
buffer_load_dwordx4 v210, s[12:15], s48 offen lds
v_mfma_f32_16x16x32_bf16 a[104:107], v[184:187], v[40:43], a[104:107]
v_mfma_f32_16x16x32_bf16 a[108:111], v[184:187], v[44:47], a[108:111]
ds_read_b64_tr_b16 v[196:197], v242 offset:20480
s_waitcnt lgkmcnt(1)
v_mfma_f32_16x16x32_bf16 a[96:99], v[188:191], v[48:51], a[96:99]
ds_read_b64_tr_b16 v[198:199], v242 offset:22528
v_mfma_f32_16x16x32_bf16 a[100:103], v[188:191], v[52:55], a[100:103]
buffer_load_dwordx4 v211, s[12:15], s48 offen offset:1024 lds
v_mfma_f32_16x16x32_bf16 a[104:107], v[188:191], v[56:59], a[104:107]
v_mfma_f32_16x16x32_bf16 a[108:111], v[188:191], v[60:63], a[108:111]
ds_read_b64_tr_b16 v[200:201], v242 offset:24576
v_mfma_f32_16x16x32_bf16 a[112:115], v[192:195], v[0:3], a[112:115]
ds_read_b64_tr_b16 v[202:203], v242 offset:26624
v_mfma_f32_16x16x32_bf16 a[116:119], v[192:195], v[4:7], a[116:119]
buffer_load_dwordx4 v212, s[12:15], s48 offen offset:2048 lds
v_mfma_f32_16x16x32_bf16 a[120:123], v[192:195], v[8:11], a[120:123]
v_mfma_f32_16x16x32_bf16 a[124:127], v[192:195], v[12:15], a[124:127]
ds_read_b64_tr_b16 v[204:205], v242 offset:28672
s_waitcnt lgkmcnt(1)
v_mfma_f32_16x16x32_bf16 a[112:115], v[196:199], v[16:19], a[112:115]
ds_read_b64_tr_b16 v[206:207], v242 offset:30720
v_mfma_f32_16x16x32_bf16 a[116:119], v[196:199], v[20:23], a[116:119]
buffer_load_dwordx4 v213, s[12:15], s48 offen offset:3072 lds
v_mfma_f32_16x16x32_bf16 a[120:123], v[196:199], v[24:27], a[120:123]
v_mfma_f32_16x16x32_bf16 a[124:127], v[196:199], v[28:31], a[124:127]
s_waitcnt vmcnt(16)
s_barrier
ds_read_b64_tr_b16 v[160:161], v242 offset:32768
v_mfma_f32_16x16x32_bf16 a[112:115], v[200:203], v[32:35], a[112:115]
ds_read_b64_tr_b16 v[162:163], v242 offset:34816
v_mfma_f32_16x16x32_bf16 a[116:119], v[200:203], v[36:39], a[116:119]
s_add_u32 m0, s37, 32768
s_add_u32 s49, s42, 2097152
buffer_load_dwordx4 v210, s[12:15], s49 offen lds
v_mfma_f32_16x16x32_bf16 a[120:123], v[200:203], v[40:43], a[120:123]
v_mfma_f32_16x16x32_bf16 a[124:127], v[200:203], v[44:47], a[124:127]
ds_read_b64_tr_b16 v[164:165], v242 offset:36864
s_waitcnt lgkmcnt(1)
v_mfma_f32_16x16x32_bf16 a[112:115], v[204:207], v[48:51], a[112:115]
ds_read_b64_tr_b16 v[166:167], v242 offset:38912
v_mfma_f32_16x16x32_bf16 a[116:119], v[204:207], v[52:55], a[116:119]
buffer_load_dwordx4 v211, s[12:15], s49 offen offset:1024 lds
v_mfma_f32_16x16x32_bf16 a[120:123], v[204:207], v[56:59], a[120:123]
v_mfma_f32_16x16x32_bf16 a[124:127], v[204:207], v[60:63], a[124:127]
ds_read_b64_tr_b16 v[168:169], v242 offset:40960
v_mfma_f32_16x16x32_bf16 a[128:131], v[160:163], v[0:3], a[128:131]
ds_read_b64_tr_b16 v[170:171], v242 offset:43008
v_mfma_f32_16x16x32_bf16 a[132:135], v[160:163], v[4:7], a[132:135]
buffer_load_dwordx4 v212, s[12:15], s49 offen offset:2048 lds
v_mfma_f32_16x16x32_bf16 a[136:139], v[160:163], v[8:11], a[136:139]
v_mfma_f32_16x16x32_bf16 a[140:143], v[160:163], v[12:15], a[140:143]
ds_read_b64_tr_b16 v[172:173], v242 offset:45056
s_waitcnt lgkmcnt(1)
v_mfma_f32_16x16x32_bf16 a[128:131], v[164:167], v[16:19], a[128:131]
ds_read_b64_tr_b16 v[174:175], v242 offset:47104
v_mfma_f32_16x16x32_bf16 a[132:135], v[164:167], v[20:23], a[132:135]
buffer_load_dwordx4 v213, s[12:15], s49 offen offset:3072 lds
v_mfma_f32_16x16x32_bf16 a[136:139], v[164:167], v[24:27], a[136:139]
v_mfma_f32_16x16x32_bf16 a[140:143], v[164:167], v[28:31], a[140:143]
v_mfma_f32_16x16x32_bf16 a[128:131], v[168:171], v[32:35], a[128:131]
v_mfma_f32_16x16x32_bf16 a[132:135], v[168:171], v[36:39], a[132:135]
v_mfma_f32_16x16x32_bf16 a[136:139], v[168:171], v[40:43], a[136:139]
v_mfma_f32_16x16x32_bf16 a[140:143], v[168:171], v[44:47], a[140:143]
s_waitcnt lgkmcnt(0)
v_mfma_f32_16x16x32_bf16 a[128:131], v[172:175], v[48:51], a[128:131]
v_mfma_f32_16x16x32_bf16 a[132:135], v[172:175], v[52:55], a[132:135]
v_mfma_f32_16x16x32_bf16 a[136:139], v[172:175], v[56:59], a[136:139]
v_mfma_f32_16x16x32_bf16 a[140:143], v[172:175], v[60:63], a[140:143]
L_Q:
s_waitcnt vmcnt(16)
s_barrier
v_add_u32 v218, 65536, v228
v_xor_b32 v219, 8, v218
v_xor_b32 v220, 64, v218
v_xor_b32 v221, 72, v218
v_xor_b32 v222, 128, v218
v_xor_b32 v223, 136, v218
v_xor_b32 v224, 192, v218
v_xor_b32 v225, 200, v218
ds_read_b64_tr_b16 v[176:177], v218 offset:49152
ds_read_b64_tr_b16 v[178:179], v218 offset:50176
ds_read_b64_tr_b16 v[180:181], v219 offset:49152
ds_read_b64_tr_b16 v[182:183], v219 offset:50176
ds_read_b64_tr_b16 v[184:185], v220 offset:49152
ds_read_b64_tr_b16 v[186:187], v220 offset:50176
ds_read_b64_tr_b16 v[188:189], v221 offset:49152
ds_read_b64_tr_b16 v[190:191], v221 offset:50176
ds_read_b64_tr_b16 v[192:193], v222 offset:49152
ds_read_b64_tr_b16 v[194:195], v222 offset:50176
s_waitcnt lgkmcnt(6)
v_mfma_f32_16x16x32_bf16 v[128:131], v[176:179], a[144:147], 0
s_add_u32 m0, s37, 49152
s_add_u32 s48, s42, 2621440
buffer_load_dwordx4 v210, s[12:15], s48 offen lds
ds_read_b64_tr_b16 v[196:197], v223 offset:49152
ds_read_b64_tr_b16 v[198:199], v223 offset:50176
v_mfma_f32_16x16x32_bf16 v[132:135], v[180:183], a[144:147], 0
ds_read_b64_tr_b16 v[200:201], v224 offset:49152
ds_read_b64_tr_b16 v[202:203], v224 offset:50176
s_waitcnt lgkmcnt(6)
v_mfma_f32_16x16x32_bf16 v[136:139], v[184:187], a[144:147], 0
ds_read_b64_tr_b16 v[204:205], v225 offset:49152
ds_read_b64_tr_b16 v[206:207], v225 offset:50176
v_mfma_f32_16x16x32_bf16 v[140:143], v[188:191], a[144:147], 0
ds_read_b64_tr_b16 v[160:161], v218 offset:51200
ds_read_b64_tr_b16 v[162:163], v218 offset:52224
s_waitcnt lgkmcnt(6)
v_mfma_f32_16x16x32_bf16 v[144:147], v[192:195], a[144:147], 0
buffer_load_dwordx4 v211, s[12:15], s48 offen offset:1024 lds
ds_read_b64_tr_b16 v[164:165], v219 offset:51200
ds_read_b64_tr_b16 v[166:167], v219 offset:52224
v_mfma_f32_16x16x32_bf16 v[148:151], v[196:199], a[144:147], 0
ds_read_b64_tr_b16 v[168:169], v220 offset:51200
ds_read_b64_tr_b16 v[170:171], v220 offset:52224
s_waitcnt lgkmcnt(6)
v_mfma_f32_16x16x32_bf16 v[152:155], v[200:203], a[144:147], 0
ds_read_b64_tr_b16 v[172:173], v221 offset:51200
ds_read_b64_tr_b16 v[174:175], v221 offset:52224
v_mfma_f32_16x16x32_bf16 v[156:159], v[204:207], a[144:147], 0
ds_read_b64_tr_b16 v[176:177], v222 offset:51200
ds_read_b64_tr_b16 v[178:179], v222 offset:52224
s_waitcnt lgkmcnt(6)
v_mfma_f32_16x16x32_bf16 v[128:131], v[160:163], a[148:151], v[128:131]
buffer_load_dwordx4 v212, s[12:15], s48 offen offset:2048 lds
ds_read_b64_tr_b16 v[180:181], v223 offset:51200
ds_read_b64_tr_b16 v[182:183], v223 offset:52224
v_mfma_f32_16x16x32_bf16 v[132:135], v[164:167], a[148:151], v[132:135]
ds_read_b64_tr_b16 v[184:185], v224 offset:51200
ds_read_b64_tr_b16 v[186:187], v224 offset:52224
s_waitcnt lgkmcnt(6)
v_mfma_f32_16x16x32_bf16 v[136:139], v[168:171], a[148:151], v[136:139]
ds_read_b64_tr_b16 v[188:189], v225 offset:51200
ds_read_b64_tr_b16 v[190:191], v225 offset:52224
v_mfma_f32_16x16x32_bf16 v[140:143], v[172:175], a[148:151], v[140:143]
buffer_load_dwordx4 v213, s[12:15], s48 offen offset:3072 lds
s_waitcnt vmcnt(16)
s_barrier
v_add_u32 v218, 131072, v228
v_xor_b32 v219, 8, v218
v_xor_b32 v220, 64, v218
v_xor_b32 v221, 72, v218
v_xor_b32 v222, 128, v218
v_xor_b32 v223, 136, v218
v_xor_b32 v224, 192, v218
v_xor_b32 v225, 200, v218
ds_read_b64_tr_b16 v[192:193], v218 offset:0
ds_read_b64_tr_b16 v[194:195], v218 offset:1024
s_waitcnt lgkmcnt(6)
v_mfma_f32_16x16x32_bf16 v[144:147], v[176:179], a[148:151], v[144:147]
s_add_u32 m0, s37, 65536
s_add_u32 s49, s42, 3145728
buffer_load_dwordx4 v210, s[12:15], s49 offen lds
ds_read_b64_tr_b16 v[196:197], v219 offset:0
ds_read_b64_tr_b16 v[198:199], v219 offset:1024
v_mfma_f32_16x16x32_bf16 v[148:151], v[180:183], a[148:151], v[148:151]
ds_read_b64_tr_b16 v[200:201], v220 offset:0
ds_read_b64_tr_b16 v[202:203], v220 offset:1024
s_waitcnt lgkmcnt(6)
v_mfma_f32_16x16x32_bf16 v[152:155], v[184:187], a[148:151], v[152:155]
ds_read_b64_tr_b16 v[204:205], v221 offset:0
ds_read_b64_tr_b16 v[206:207], v221 offset:1024
v_mfma_f32_16x16x32_bf16 v[156:159], v[188:191], a[148:151], v[156:159]
ds_read_b64_tr_b16 v[160:161], v222 offset:0
ds_read_b64_tr_b16 v[162:163], v222 offset:1024
s_waitcnt lgkmcnt(6)
v_mfma_f32_16x16x32_bf16 v[128:131], v[192:195], a[152:155], v[128:131]
buffer_load_dwordx4 v211, s[12:15], s49 offen offset:1024 lds
ds_read_b64_tr_b16 v[164:165], v223 offset:0
ds_read_b64_tr_b16 v[166:167], v223 offset:1024
v_mfma_f32_16x16x32_bf16 v[132:135], v[196:199], a[152:155], v[132:135]
ds_read_b64_tr_b16 v[168:169], v224 offset:0
ds_read_b64_tr_b16 v[170:171], v224 offset:1024
s_waitcnt lgkmcnt(6)
v_mfma_f32_16x16x32_bf16 v[136:139], v[200:203], a[152:155], v[136:139]
ds_read_b64_tr_b16 v[172:173], v225 offset:0
ds_read_b64_tr_b16 v[174:175], v225 offset:1024
v_mfma_f32_16x16x32_bf16 v[140:143], v[204:207], a[152:155], v[140:143]
ds_read_b64_tr_b16 v[176:177], v218 offset:2048
ds_read_b64_tr_b16 v[178:179], v218 offset:3072
s_waitcnt lgkmcnt(6)
v_mfma_f32_16x16x32_bf16 v[144:147], v[160:163], a[152:155], v[144:147]
buffer_load_dwordx4 v212, s[12:15], s49 offen offset:2048 lds
ds_read_b64_tr_b16 v[180:181], v219 offset:2048
ds_read_b64_tr_b16 v[182:183], v219 offset:3072
v_mfma_f32_16x16x32_bf16 v[148:151], v[164:167], a[152:155], v[148:151]
ds_read_b64_tr_b16 v[184:185], v220 offset:2048
ds_read_b64_tr_b16 v[186:187], v220 offset:3072
s_waitcnt lgkmcnt(6)
v_mfma_f32_16x16x32_bf16 v[152:155], v[168:171], a[152:155], v[152:155]
ds_read_b64_tr_b16 v[188:189], v221 offset:2048
ds_read_b64_tr_b16 v[190:191], v221 offset:3072
v_mfma_f32_16x16x32_bf16 v[156:159], v[172:175], a[152:155], v[156:159]
ds_read_b64_tr_b16 v[192:193], v222 offset:2048
ds_read_b64_tr_b16 v[194:195], v222 offset:3072
s_waitcnt lgkmcnt(6)
v_mfma_f32_16x16x32_bf16 v[128:131], v[176:179], a[156:159], v[128:131]
buffer_load_dwordx4 v213, s[12:15], s49 offen offset:3072 lds
ds_read_b64_tr_b16 v[196:197], v223 offset:2048
ds_read_b64_tr_b16 v[198:199], v223 offset:3072
v_mfma_f32_16x16x32_bf16 v[132:135], v[180:183], a[156:159], v[132:135]
ds_read_b64_tr_b16 v[200:201], v224 offset:2048
ds_read_b64_tr_b16 v[202:203], v224 offset:3072
s_waitcnt lgkmcnt(6)
v_mfma_f32_16x16x32_bf16 v[136:139], v[184:187], a[156:159], v[136:139]
ds_read_b64_tr_b16 v[204:205], v225 offset:2048
ds_read_b64_tr_b16 v[206:207], v225 offset:3072
v_mfma_f32_16x16x32_bf16 v[140:143], v[188:191], a[156:159], v[140:143]
s_waitcnt vmcnt(16)
s_barrier
v_mov_b32 v218, v228
v_xor_b32 v219, 8, v218
v_xor_b32 v220, 64, v218
v_xor_b32 v221, 72, v218
v_xor_b32 v222, 128, v218
v_xor_b32 v223, 136, v218
v_xor_b32 v224, 192, v218
v_xor_b32 v225, 200, v218
ds_read_b64_tr_b16 v[160:161], v218 offset:0
ds_read_b64_tr_b16 v[162:163], v218 offset:1024
s_waitcnt lgkmcnt(6)
v_mfma_f32_16x16x32_bf16 v[144:147], v[192:195], a[156:159], v[144:147]
s_add_u32 m0, s37, 81920
s_add_u32 s48, s42, 3670016
buffer_load_dwordx4 v210, s[12:15], s48 offen lds
ds_read_b64_tr_b16 v[164:165], v219 offset:0
ds_read_b64_tr_b16 v[166:167], v219 offset:1024
v_mfma_f32_16x16x32_bf16 v[148:151], v[196:199], a[156:159], v[148:151]
ds_read_b64_tr_b16 v[168:169], v220 offset:0
ds_read_b64_tr_b16 v[170:171], v220 offset:1024
s_waitcnt lgkmcnt(6)
v_mfma_f32_16x16x32_bf16 v[152:155], v[200:203], a[156:159], v[152:155]
ds_read_b64_tr_b16 v[172:173], v221 offset:0
ds_read_b64_tr_b16 v[174:175], v221 offset:1024
v_mfma_f32_16x16x32_bf16 v[156:159], v[204:207], a[156:159], v[156:159]
ds_read_b64_tr_b16 v[176:177], v222 offset:0
ds_read_b64_tr_b16 v[178:179], v222 offset:1024
s_waitcnt lgkmcnt(6)
v_mfma_f32_16x16x32_bf16 v[128:131], v[160:163], a[160:163], v[128:131]
buffer_load_dwordx4 v211, s[12:15], s48 offen offset:1024 lds
ds_read_b64_tr_b16 v[180:181], v223 offset:0
ds_read_b64_tr_b16 v[182:183], v223 offset:1024
v_mfma_f32_16x16x32_bf16 v[132:135], v[164:167], a[160:163], v[132:135]
ds_read_b64_tr_b16 v[184:185], v224 offset:0
ds_read_b64_tr_b16 v[186:187], v224 offset:1024
s_waitcnt lgkmcnt(6)
v_mfma_f32_16x16x32_bf16 v[136:139], v[168:171], a[160:163], v[136:139]
ds_read_b64_tr_b16 v[188:189], v225 offset:0
ds_read_b64_tr_b16 v[190:191], v225 offset:1024
v_mfma_f32_16x16x32_bf16 v[140:143], v[172:175], a[160:163], v[140:143]
ds_read_b64_tr_b16 v[192:193], v218 offset:2048
ds_read_b64_tr_b16 v[194:195], v218 offset:3072
s_waitcnt lgkmcnt(6)
v_mfma_f32_16x16x32_bf16 v[144:147], v[176:179], a[160:163], v[144:147]
buffer_load_dwordx4 v212, s[12:15], s48 offen offset:2048 lds
ds_read_b64_tr_b16 v[196:197], v219 offset:2048
ds_read_b64_tr_b16 v[198:199], v219 offset:3072
v_mfma_f32_16x16x32_bf16 v[148:151], v[180:183], a[160:163], v[148:151]
ds_read_b64_tr_b16 v[200:201], v220 offset:2048
ds_read_b64_tr_b16 v[202:203], v220 offset:3072
s_waitcnt lgkmcnt(6)
v_mfma_f32_16x16x32_bf16 v[152:155], v[184:187], a[160:163], v[152:155]
ds_read_b64_tr_b16 v[204:205], v221 offset:2048
ds_read_b64_tr_b16 v[206:207], v221 offset:3072
v_mfma_f32_16x16x32_bf16 v[156:159], v[188:191], a[160:163], v[156:159]
ds_read_b64_tr_b16 v[160:161], v222 offset:2048
ds_read_b64_tr_b16 v[162:163], v222 offset:3072
s_waitcnt lgkmcnt(6)
v_mfma_f32_16x16x32_bf16 v[128:131], v[192:195], a[164:167], v[128:131]
buffer_load_dwordx4 v213, s[12:15], s48 offen offset:3072 lds
ds_read_b64_tr_b16 v[164:165], v223 offset:2048
ds_read_b64_tr_b16 v[166:167], v223 offset:3072
v_mfma_f32_16x16x32_bf16 v[132:135], v[196:199], a[164:167], v[132:135]
ds_read_b64_tr_b16 v[168:169], v224 offset:2048
ds_read_b64_tr_b16 v[170:171], v224 offset:3072
s_waitcnt lgkmcnt(6)
v_mfma_f32_16x16x32_bf16 v[136:139], v[200:203], a[164:167], v[136:139]
ds_read_b64_tr_b16 v[172:173], v225 offset:2048
ds_read_b64_tr_b16 v[174:175], v225 offset:3072
v_mfma_f32_16x16x32_bf16 v[140:143], v[204:207], a[164:167], v[140:143]
s_waitcnt vmcnt(16)
s_barrier
ds_read_b64_tr_b16 v[176:177], v218 offset:16384
ds_read_b64_tr_b16 v[178:179], v218 offset:17408
s_waitcnt lgkmcnt(6)
v_mfma_f32_16x16x32_bf16 v[144:147], v[160:163], a[164:167], v[144:147]
s_add_u32 m0, s37, 98304
s_add_u32 s49, s42, 4194304
buffer_load_dwordx4 v210, s[12:15], s49 offen lds
ds_read_b64_tr_b16 v[180:181], v219 offset:16384
ds_read_b64_tr_b16 v[182:183], v219 offset:17408
v_mfma_f32_16x16x32_bf16 v[148:151], v[164:167], a[164:167], v[148:151]
ds_read_b64_tr_b16 v[184:185], v220 offset:16384
ds_read_b64_tr_b16 v[186:187], v220 offset:17408
s_waitcnt lgkmcnt(6)
v_mfma_f32_16x16x32_bf16 v[152:155], v[168:171], a[164:167], v[152:155]
ds_read_b64_tr_b16 v[188:189], v221 offset:16384
ds_read_b64_tr_b16 v[190:191], v221 offset:17408
v_mfma_f32_16x16x32_bf16 v[156:159], v[172:175], a[164:167], v[156:159]
ds_read_b64_tr_b16 v[192:193], v222 offset:16384
ds_read_b64_tr_b16 v[194:195], v222 offset:17408
s_waitcnt lgkmcnt(6)
v_mfma_f32_16x16x32_bf16 v[128:131], v[176:179], a[168:171], v[128:131]
buffer_load_dwordx4 v211, s[12:15], s49 offen offset:1024 lds
ds_read_b64_tr_b16 v[196:197], v223 offset:16384
ds_read_b64_tr_b16 v[198:199], v223 offset:17408
v_mfma_f32_16x16x32_bf16 v[132:135], v[180:183], a[168:171], v[132:135]
ds_read_b64_tr_b16 v[200:201], v224 offset:16384
ds_read_b64_tr_b16 v[202:203], v224 offset:17408
s_waitcnt lgkmcnt(6)
v_mfma_f32_16x16x32_bf16 v[136:139], v[184:187], a[168:171], v[136:139]
ds_read_b64_tr_b16 v[204:205], v225 offset:16384
ds_read_b64_tr_b16 v[206:207], v225 offset:17408
v_mfma_f32_16x16x32_bf16 v[140:143], v[188:191], a[168:171], v[140:143]
ds_read_b64_tr_b16 v[160:161], v218 offset:18432
ds_read_b64_tr_b16 v[162:163], v218 offset:19456
s_waitcnt lgkmcnt(6)
v_mfma_f32_16x16x32_bf16 v[144:147], v[192:195], a[168:171], v[144:147]
buffer_load_dwordx4 v212, s[12:15], s49 offen offset:2048 lds
ds_read_b64_tr_b16 v[164:165], v219 offset:18432
ds_read_b64_tr_b16 v[166:167], v219 offset:19456
v_mfma_f32_16x16x32_bf16 v[148:151], v[196:199], a[168:171], v[148:151]
ds_read_b64_tr_b16 v[168:169], v220 offset:18432
ds_read_b64_tr_b16 v[170:171], v220 offset:19456
s_waitcnt lgkmcnt(6)
v_mfma_f32_16x16x32_bf16 v[152:155], v[200:203], a[168:171], v[152:155]
ds_read_b64_tr_b16 v[172:173], v221 offset:18432
ds_read_b64_tr_b16 v[174:175], v221 offset:19456
v_mfma_f32_16x16x32_bf16 v[156:159], v[204:207], a[168:171], v[156:159]
ds_read_b64_tr_b16 v[176:177], v222 offset:18432
ds_read_b64_tr_b16 v[178:179], v222 offset:19456
s_waitcnt lgkmcnt(6)
v_mfma_f32_16x16x32_bf16 v[128:131], v[160:163], a[172:175], v[128:131]
buffer_load_dwordx4 v213, s[12:15], s49 offen offset:3072 lds
ds_read_b64_tr_b16 v[180:181], v223 offset:18432
ds_read_b64_tr_b16 v[182:183], v223 offset:19456
v_mfma_f32_16x16x32_bf16 v[132:135], v[164:167], a[172:175], v[132:135]
ds_read_b64_tr_b16 v[184:185], v224 offset:18432
ds_read_b64_tr_b16 v[186:187], v224 offset:19456
s_waitcnt lgkmcnt(6)
v_mfma_f32_16x16x32_bf16 v[136:139], v[168:171], a[172:175], v[136:139]
ds_read_b64_tr_b16 v[188:189], v225 offset:18432
ds_read_b64_tr_b16 v[190:191], v225 offset:19456
v_mfma_f32_16x16x32_bf16 v[140:143], v[172:175], a[172:175], v[140:143]
s_waitcnt vmcnt(16)
s_barrier
ds_read_b64_tr_b16 v[192:193], v218 offset:32768
ds_read_b64_tr_b16 v[194:195], v218 offset:33792
s_waitcnt lgkmcnt(6)
v_mfma_f32_16x16x32_bf16 v[144:147], v[176:179], a[172:175], v[144:147]
s_add_u32 m0, s37, 0
s_add_u32 s48, s41, 0
buffer_load_dwordx4 v208, s[4:7], s48 offen nt lds
ds_read_b64_tr_b16 v[196:197], v219 offset:32768
ds_read_b64_tr_b16 v[198:199], v219 offset:33792
v_mfma_f32_16x16x32_bf16 v[148:151], v[180:183], a[172:175], v[148:151]
ds_read_b64_tr_b16 v[200:201], v220 offset:32768
ds_read_b64_tr_b16 v[202:203], v220 offset:33792
s_waitcnt lgkmcnt(6)
v_mfma_f32_16x16x32_bf16 v[152:155], v[184:187], a[172:175], v[152:155]
ds_read_b64_tr_b16 v[204:205], v221 offset:32768
ds_read_b64_tr_b16 v[206:207], v221 offset:33792
v_mfma_f32_16x16x32_bf16 v[156:159], v[188:191], a[172:175], v[156:159]
ds_read_b64_tr_b16 v[160:161], v222 offset:32768
ds_read_b64_tr_b16 v[162:163], v222 offset:33792
s_waitcnt lgkmcnt(6)
v_mfma_f32_16x16x32_bf16 v[128:131], v[192:195], a[176:179], v[128:131]
buffer_load_dwordx4 v208, s[4:7], s48 offen offset:1024 nt lds
ds_read_b64_tr_b16 v[164:165], v223 offset:32768
ds_read_b64_tr_b16 v[166:167], v223 offset:33792
v_mfma_f32_16x16x32_bf16 v[132:135], v[196:199], a[176:179], v[132:135]
ds_read_b64_tr_b16 v[168:169], v224 offset:32768
ds_read_b64_tr_b16 v[170:171], v224 offset:33792
s_waitcnt lgkmcnt(6)
v_mfma_f32_16x16x32_bf16 v[136:139], v[200:203], a[176:179], v[136:139]
ds_read_b64_tr_b16 v[172:173], v225 offset:32768
ds_read_b64_tr_b16 v[174:175], v225 offset:33792
v_mfma_f32_16x16x32_bf16 v[140:143], v[204:207], a[176:179], v[140:143]
ds_read_b64_tr_b16 v[176:177], v218 offset:34816
ds_read_b64_tr_b16 v[178:179], v218 offset:35840
s_waitcnt lgkmcnt(6)
v_mfma_f32_16x16x32_bf16 v[144:147], v[160:163], a[176:179], v[144:147]
buffer_load_dwordx4 v208, s[4:7], s48 offen offset:2048 nt lds
ds_read_b64_tr_b16 v[180:181], v219 offset:34816
ds_read_b64_tr_b16 v[182:183], v219 offset:35840
v_mfma_f32_16x16x32_bf16 v[148:151], v[164:167], a[176:179], v[148:151]
ds_read_b64_tr_b16 v[184:185], v220 offset:34816
ds_read_b64_tr_b16 v[186:187], v220 offset:35840
s_waitcnt lgkmcnt(6)
v_mfma_f32_16x16x32_bf16 v[152:155], v[168:171], a[176:179], v[152:155]
ds_read_b64_tr_b16 v[188:189], v221 offset:34816
ds_read_b64_tr_b16 v[190:191], v221 offset:35840
v_mfma_f32_16x16x32_bf16 v[156:159], v[172:175], a[176:179], v[156:159]
ds_read_b64_tr_b16 v[192:193], v222 offset:34816
ds_read_b64_tr_b16 v[194:195], v222 offset:35840
s_waitcnt lgkmcnt(6)
v_mfma_f32_16x16x32_bf16 v[128:131], v[176:179], a[180:183], v[128:131]
buffer_load_dwordx4 v208, s[4:7], s48 offen offset:3072 nt lds
ds_read_b64_tr_b16 v[196:197], v223 offset:34816
ds_read_b64_tr_b16 v[198:199], v223 offset:35840
v_mfma_f32_16x16x32_bf16 v[132:135], v[180:183], a[180:183], v[132:135]
ds_read_b64_tr_b16 v[200:201], v224 offset:34816
ds_read_b64_tr_b16 v[202:203], v224 offset:35840
s_waitcnt lgkmcnt(6)
v_mfma_f32_16x16x32_bf16 v[136:139], v[184:187], a[180:183], v[136:139]
ds_read_b64_tr_b16 v[204:205], v225 offset:34816
ds_read_b64_tr_b16 v[206:207], v225 offset:35840
v_mfma_f32_16x16x32_bf16 v[140:143], v[188:191], a[180:183], v[140:143]
s_waitcnt vmcnt(16)
s_barrier
ds_read_b64_tr_b16 v[160:161], v218 offset:49152
ds_read_b64_tr_b16 v[162:163], v218 offset:50176
s_waitcnt lgkmcnt(6)
v_mfma_f32_16x16x32_bf16 v[144:147], v[192:195], a[180:183], v[144:147]
s_add_u32 m0, s37, 16384
s_add_u32 s49, s41, 16384
buffer_load_dwordx4 v208, s[4:7], s49 offen nt lds
ds_read_b64_tr_b16 v[164:165], v219 offset:49152
ds_read_b64_tr_b16 v[166:167], v219 offset:50176
v_mfma_f32_16x16x32_bf16 v[148:151], v[196:199], a[180:183], v[148:151]
ds_read_b64_tr_b16 v[168:169], v220 offset:49152
ds_read_b64_tr_b16 v[170:171], v220 offset:50176
s_waitcnt lgkmcnt(6)
v_mfma_f32_16x16x32_bf16 v[152:155], v[200:203], a[180:183], v[152:155]
ds_read_b64_tr_b16 v[172:173], v221 offset:49152
ds_read_b64_tr_b16 v[174:175], v221 offset:50176
v_mfma_f32_16x16x32_bf16 v[156:159], v[204:207], a[180:183], v[156:159]
ds_read_b64_tr_b16 v[176:177], v222 offset:49152
ds_read_b64_tr_b16 v[178:179], v222 offset:50176
s_waitcnt lgkmcnt(6)
v_mfma_f32_16x16x32_bf16 v[128:131], v[160:163], a[184:187], v[128:131]
buffer_load_dwordx4 v208, s[4:7], s49 offen offset:1024 nt lds
ds_read_b64_tr_b16 v[180:181], v223 offset:49152
ds_read_b64_tr_b16 v[182:183], v223 offset:50176
v_mfma_f32_16x16x32_bf16 v[132:135], v[164:167], a[184:187], v[132:135]
ds_read_b64_tr_b16 v[184:185], v224 offset:49152
ds_read_b64_tr_b16 v[186:187], v224 offset:50176
s_waitcnt lgkmcnt(6)
v_mfma_f32_16x16x32_bf16 v[136:139], v[168:171], a[184:187], v[136:139]
ds_read_b64_tr_b16 v[188:189], v225 offset:49152
ds_read_b64_tr_b16 v[190:191], v225 offset:50176
v_mfma_f32_16x16x32_bf16 v[140:143], v[172:175], a[184:187], v[140:143]
ds_read_b64_tr_b16 v[192:193], v218 offset:51200
ds_read_b64_tr_b16 v[194:195], v218 offset:52224
s_waitcnt lgkmcnt(6)
v_mfma_f32_16x16x32_bf16 v[144:147], v[176:179], a[184:187], v[144:147]
buffer_load_dwordx4 v208, s[4:7], s49 offen offset:2048 nt lds
ds_read_b64_tr_b16 v[196:197], v219 offset:51200
ds_read_b64_tr_b16 v[198:199], v219 offset:52224
v_mfma_f32_16x16x32_bf16 v[148:151], v[180:183], a[184:187], v[148:151]
ds_read_b64_tr_b16 v[200:201], v220 offset:51200
ds_read_b64_tr_b16 v[202:203], v220 offset:52224
s_waitcnt lgkmcnt(6)
v_mfma_f32_16x16x32_bf16 v[152:155], v[184:187], a[184:187], v[152:155]
ds_read_b64_tr_b16 v[204:205], v221 offset:51200
ds_read_b64_tr_b16 v[206:207], v221 offset:52224
v_mfma_f32_16x16x32_bf16 v[156:159], v[188:191], a[184:187], v[156:159]
ds_read_b64_tr_b16 v[160:161], v222 offset:51200
ds_read_b64_tr_b16 v[162:163], v222 offset:52224
s_waitcnt lgkmcnt(6)
v_mfma_f32_16x16x32_bf16 v[128:131], v[192:195], a[188:191], v[128:131]
buffer_load_dwordx4 v208, s[4:7], s49 offen offset:3072 nt lds
ds_read_b64_tr_b16 v[164:165], v223 offset:51200
ds_read_b64_tr_b16 v[166:167], v223 offset:52224
v_mfma_f32_16x16x32_bf16 v[132:135], v[196:199], a[188:191], v[132:135]
ds_read_b64_tr_b16 v[168:169], v224 offset:51200
ds_read_b64_tr_b16 v[170:171], v224 offset:52224
s_waitcnt lgkmcnt(6)
v_mfma_f32_16x16x32_bf16 v[136:139], v[200:203], a[188:191], v[136:139]
ds_read_b64_tr_b16 v[172:173], v225 offset:51200
ds_read_b64_tr_b16 v[174:175], v225 offset:52224
v_mfma_f32_16x16x32_bf16 v[140:143], v[204:207], a[188:191], v[140:143]
s_waitcnt vmcnt(16)
s_barrier
v_add_u32 v218, 65536, v228
v_xor_b32 v219, 8, v218
v_xor_b32 v220, 64, v218
v_xor_b32 v221, 72, v218
v_xor_b32 v222, 128, v218
v_xor_b32 v223, 136, v218
v_xor_b32 v224, 192, v218
v_xor_b32 v225, 200, v218
ds_read_b64_tr_b16 v[176:177], v218 offset:0
ds_read_b64_tr_b16 v[178:179], v218 offset:1024
s_waitcnt lgkmcnt(6)
v_mfma_f32_16x16x32_bf16 v[144:147], v[160:163], a[188:191], v[144:147]
s_add_u32 m0, s37, 32768
s_add_u32 s48, s41, 32768
buffer_load_dwordx4 v208, s[4:7], s48 offen nt lds
ds_read_b64_tr_b16 v[180:181], v219 offset:0
ds_read_b64_tr_b16 v[182:183], v219 offset:1024
v_mfma_f32_16x16x32_bf16 v[148:151], v[164:167], a[188:191], v[148:151]
ds_read_b64_tr_b16 v[184:185], v220 offset:0
ds_read_b64_tr_b16 v[186:187], v220 offset:1024
s_waitcnt lgkmcnt(6)
v_mfma_f32_16x16x32_bf16 v[152:155], v[168:171], a[188:191], v[152:155]
ds_read_b64_tr_b16 v[188:189], v221 offset:0
ds_read_b64_tr_b16 v[190:191], v221 offset:1024
v_mfma_f32_16x16x32_bf16 v[156:159], v[172:175], a[188:191], v[156:159]
ds_read_b64_tr_b16 v[192:193], v222 offset:0
ds_read_b64_tr_b16 v[194:195], v222 offset:1024
s_waitcnt lgkmcnt(6)
v_mfma_f32_16x16x32_bf16 v[128:131], v[176:179], a[192:195], v[128:131]
buffer_load_dwordx4 v208, s[4:7], s48 offen offset:1024 nt lds
ds_read_b64_tr_b16 v[196:197], v223 offset:0
ds_read_b64_tr_b16 v[198:199], v223 offset:1024
v_mfma_f32_16x16x32_bf16 v[132:135], v[180:183], a[192:195], v[132:135]
ds_read_b64_tr_b16 v[200:201], v224 offset:0
ds_read_b64_tr_b16 v[202:203], v224 offset:1024
s_waitcnt lgkmcnt(6)
v_mfma_f32_16x16x32_bf16 v[136:139], v[184:187], a[192:195], v[136:139]
ds_read_b64_tr_b16 v[204:205], v225 offset:0
ds_read_b64_tr_b16 v[206:207], v225 offset:1024
v_mfma_f32_16x16x32_bf16 v[140:143], v[188:191], a[192:195], v[140:143]
ds_read_b64_tr_b16 v[160:161], v218 offset:2048
ds_read_b64_tr_b16 v[162:163], v218 offset:3072
s_waitcnt lgkmcnt(6)
v_mfma_f32_16x16x32_bf16 v[144:147], v[192:195], a[192:195], v[144:147]
buffer_load_dwordx4 v208, s[4:7], s48 offen offset:2048 nt lds
ds_read_b64_tr_b16 v[164:165], v219 offset:2048
ds_read_b64_tr_b16 v[166:167], v219 offset:3072
v_mfma_f32_16x16x32_bf16 v[148:151], v[196:199], a[192:195], v[148:151]
ds_read_b64_tr_b16 v[168:169], v220 offset:2048
ds_read_b64_tr_b16 v[170:171], v220 offset:3072
s_waitcnt lgkmcnt(6)
v_mfma_f32_16x16x32_bf16 v[152:155], v[200:203], a[192:195], v[152:155]
ds_read_b64_tr_b16 v[172:173], v221 offset:2048
ds_read_b64_tr_b16 v[174:175], v221 offset:3072
v_mfma_f32_16x16x32_bf16 v[156:159], v[204:207], a[192:195], v[156:159]
ds_read_b64_tr_b16 v[176:177], v222 offset:2048
ds_read_b64_tr_b16 v[178:179], v222 offset:3072
s_waitcnt lgkmcnt(6)
v_mfma_f32_16x16x32_bf16 v[128:131], v[160:163], a[196:199], v[128:131]
buffer_load_dwordx4 v208, s[4:7], s48 offen offset:3072 nt lds
ds_read_b64_tr_b16 v[180:181], v223 offset:2048
ds_read_b64_tr_b16 v[182:183], v223 offset:3072
v_mfma_f32_16x16x32_bf16 v[132:135], v[164:167], a[196:199], v[132:135]
ds_read_b64_tr_b16 v[184:185], v224 offset:2048
ds_read_b64_tr_b16 v[186:187], v224 offset:3072
s_waitcnt lgkmcnt(6)
v_mfma_f32_16x16x32_bf16 v[136:139], v[168:171], a[196:199], v[136:139]
ds_read_b64_tr_b16 v[188:189], v225 offset:2048
ds_read_b64_tr_b16 v[190:191], v225 offset:3072
v_mfma_f32_16x16x32_bf16 v[140:143], v[172:175], a[196:199], v[140:143]
s_waitcnt vmcnt(16)
s_barrier
ds_read_b64_tr_b16 v[192:193], v218 offset:16384
ds_read_b64_tr_b16 v[194:195], v218 offset:17408
s_waitcnt lgkmcnt(6)
v_mfma_f32_16x16x32_bf16 v[144:147], v[176:179], a[196:199], v[144:147]
s_add_u32 m0, s37, 49152
s_add_u32 s49, s41, 49152
buffer_load_dwordx4 v208, s[4:7], s49 offen nt lds
ds_read_b64_tr_b16 v[196:197], v219 offset:16384
ds_read_b64_tr_b16 v[198:199], v219 offset:17408
v_mfma_f32_16x16x32_bf16 v[148:151], v[180:183], a[196:199], v[148:151]
ds_read_b64_tr_b16 v[200:201], v220 offset:16384
ds_read_b64_tr_b16 v[202:203], v220 offset:17408
s_waitcnt lgkmcnt(6)
v_mfma_f32_16x16x32_bf16 v[152:155], v[184:187], a[196:199], v[152:155]
ds_read_b64_tr_b16 v[204:205], v221 offset:16384
ds_read_b64_tr_b16 v[206:207], v221 offset:17408
v_mfma_f32_16x16x32_bf16 v[156:159], v[188:191], a[196:199], v[156:159]
ds_read_b64_tr_b16 v[160:161], v222 offset:16384
ds_read_b64_tr_b16 v[162:163], v222 offset:17408
s_waitcnt lgkmcnt(6)
v_mfma_f32_16x16x32_bf16 v[128:131], v[192:195], a[200:203], v[128:131]
buffer_load_dwordx4 v208, s[4:7], s49 offen offset:1024 nt lds
ds_read_b64_tr_b16 v[164:165], v223 offset:16384
ds_read_b64_tr_b16 v[166:167], v223 offset:17408
v_mfma_f32_16x16x32_bf16 v[132:135], v[196:199], a[200:203], v[132:135]
ds_read_b64_tr_b16 v[168:169], v224 offset:16384
ds_read_b64_tr_b16 v[170:171], v224 offset:17408
s_waitcnt lgkmcnt(6)
v_mfma_f32_16x16x32_bf16 v[136:139], v[200:203], a[200:203], v[136:139]
ds_read_b64_tr_b16 v[172:173], v225 offset:16384
ds_read_b64_tr_b16 v[174:175], v225 offset:17408
v_mfma_f32_16x16x32_bf16 v[140:143], v[204:207], a[200:203], v[140:143]
ds_read_b64_tr_b16 v[176:177], v218 offset:18432
ds_read_b64_tr_b16 v[178:179], v218 offset:19456
s_waitcnt lgkmcnt(6)
v_mfma_f32_16x16x32_bf16 v[144:147], v[160:163], a[200:203], v[144:147]
buffer_load_dwordx4 v208, s[4:7], s49 offen offset:2048 nt lds
ds_read_b64_tr_b16 v[180:181], v219 offset:18432
ds_read_b64_tr_b16 v[182:183], v219 offset:19456
v_mfma_f32_16x16x32_bf16 v[148:151], v[164:167], a[200:203], v[148:151]
ds_read_b64_tr_b16 v[184:185], v220 offset:18432
ds_read_b64_tr_b16 v[186:187], v220 offset:19456
s_waitcnt lgkmcnt(6)
v_mfma_f32_16x16x32_bf16 v[152:155], v[168:171], a[200:203], v[152:155]
ds_read_b64_tr_b16 v[188:189], v221 offset:18432
ds_read_b64_tr_b16 v[190:191], v221 offset:19456
v_mfma_f32_16x16x32_bf16 v[156:159], v[172:175], a[200:203], v[156:159]
ds_read_b64_tr_b16 v[192:193], v222 offset:18432
ds_read_b64_tr_b16 v[194:195], v222 offset:19456
s_waitcnt lgkmcnt(6)
v_mfma_f32_16x16x32_bf16 v[128:131], v[176:179], a[204:207], v[128:131]
buffer_load_dwordx4 v208, s[4:7], s49 offen offset:3072 nt lds
ds_read_b64_tr_b16 v[196:197], v223 offset:18432
ds_read_b64_tr_b16 v[198:199], v223 offset:19456
v_mfma_f32_16x16x32_bf16 v[132:135], v[180:183], a[204:207], v[132:135]
ds_read_b64_tr_b16 v[200:201], v224 offset:18432
ds_read_b64_tr_b16 v[202:203], v224 offset:19456
s_waitcnt lgkmcnt(6)
v_mfma_f32_16x16x32_bf16 v[136:139], v[184:187], a[204:207], v[136:139]
ds_read_b64_tr_b16 v[204:205], v225 offset:18432
ds_read_b64_tr_b16 v[206:207], v225 offset:19456
v_mfma_f32_16x16x32_bf16 v[140:143], v[188:191], a[204:207], v[140:143]
s_waitcnt vmcnt(16)
s_barrier
ds_read_b64_tr_b16 v[160:161], v218 offset:32768
ds_read_b64_tr_b16 v[162:163], v218 offset:33792
s_waitcnt lgkmcnt(6)
v_mfma_f32_16x16x32_bf16 v[144:147], v[192:195], a[204:207], v[144:147]
s_add_u32 m0, s37, 65536
s_add_u32 s48, s41, 65536
buffer_load_dwordx4 v208, s[4:7], s48 offen nt lds
ds_read_b64_tr_b16 v[164:165], v219 offset:32768
ds_read_b64_tr_b16 v[166:167], v219 offset:33792
v_mfma_f32_16x16x32_bf16 v[148:151], v[196:199], a[204:207], v[148:151]
ds_read_b64_tr_b16 v[168:169], v220 offset:32768
ds_read_b64_tr_b16 v[170:171], v220 offset:33792
s_waitcnt lgkmcnt(6)
v_mfma_f32_16x16x32_bf16 v[152:155], v[200:203], a[204:207], v[152:155]
ds_read_b64_tr_b16 v[172:173], v221 offset:32768
ds_read_b64_tr_b16 v[174:175], v221 offset:33792
v_mfma_f32_16x16x32_bf16 v[156:159], v[204:207], a[204:207], v[156:159]
ds_read_b64_tr_b16 v[176:177], v222 offset:32768
ds_read_b64_tr_b16 v[178:179], v222 offset:33792
s_waitcnt lgkmcnt(6)
v_mfma_f32_16x16x32_bf16 v[128:131], v[160:163], a[208:211], v[128:131]
buffer_load_dwordx4 v208, s[4:7], s48 offen offset:1024 nt lds
ds_read_b64_tr_b16 v[180:181], v223 offset:32768
ds_read_b64_tr_b16 v[182:183], v223 offset:33792
v_mfma_f32_16x16x32_bf16 v[132:135], v[164:167], a[208:211], v[132:135]
ds_read_b64_tr_b16 v[184:185], v224 offset:32768
ds_read_b64_tr_b16 v[186:187], v224 offset:33792
s_waitcnt lgkmcnt(6)
v_mfma_f32_16x16x32_bf16 v[136:139], v[168:171], a[208:211], v[136:139]
ds_read_b64_tr_b16 v[188:189], v225 offset:32768
ds_read_b64_tr_b16 v[190:191], v225 offset:33792
v_mfma_f32_16x16x32_bf16 v[140:143], v[172:175], a[208:211], v[140:143]
ds_read_b64_tr_b16 v[192:193], v218 offset:34816
ds_read_b64_tr_b16 v[194:195], v218 offset:35840
s_waitcnt lgkmcnt(6)
v_mfma_f32_16x16x32_bf16 v[144:147], v[176:179], a[208:211], v[144:147]
buffer_load_dwordx4 v208, s[4:7], s48 offen offset:2048 nt lds
ds_read_b64_tr_b16 v[196:197], v219 offset:34816
ds_read_b64_tr_b16 v[198:199], v219 offset:35840
v_mfma_f32_16x16x32_bf16 v[148:151], v[180:183], a[208:211], v[148:151]
ds_read_b64_tr_b16 v[200:201], v220 offset:34816
ds_read_b64_tr_b16 v[202:203], v220 offset:35840
s_waitcnt lgkmcnt(6)
v_mfma_f32_16x16x32_bf16 v[152:155], v[184:187], a[208:211], v[152:155]
ds_read_b64_tr_b16 v[204:205], v221 offset:34816
ds_read_b64_tr_b16 v[206:207], v221 offset:35840
v_mfma_f32_16x16x32_bf16 v[156:159], v[188:191], a[208:211], v[156:159]
ds_read_b64_tr_b16 v[160:161], v222 offset:34816
ds_read_b64_tr_b16 v[162:163], v222 offset:35840
s_waitcnt lgkmcnt(6)
v_mfma_f32_16x16x32_bf16 v[128:131], v[192:195], a[212:215], v[128:131]
buffer_load_dwordx4 v208, s[4:7], s48 offen offset:3072 nt lds
ds_read_b64_tr_b16 v[164:165], v223 offset:34816
ds_read_b64_tr_b16 v[166:167], v223 offset:35840
v_mfma_f32_16x16x32_bf16 v[132:135], v[196:199], a[212:215], v[132:135]
ds_read_b64_tr_b16 v[168:169], v224 offset:34816
ds_read_b64_tr_b16 v[170:171], v224 offset:35840
s_waitcnt lgkmcnt(6)
v_mfma_f32_16x16x32_bf16 v[136:139], v[200:203], a[212:215], v[136:139]
ds_read_b64_tr_b16 v[172:173], v225 offset:34816
ds_read_b64_tr_b16 v[174:175], v225 offset:35840
v_mfma_f32_16x16x32_bf16 v[140:143], v[204:207], a[212:215], v[140:143]
s_waitcnt lgkmcnt(4)
v_mfma_f32_16x16x32_bf16 v[144:147], v[160:163], a[212:215], v[144:147]
v_mfma_f32_16x16x32_bf16 v[148:151], v[164:167], a[212:215], v[148:151]
s_waitcnt lgkmcnt(0)
v_mfma_f32_16x16x32_bf16 v[152:155], v[168:171], a[212:215], v[152:155]
v_mfma_f32_16x16x32_bf16 v[156:159], v[172:175], a[212:215], v[156:159]
s_mov_b32 s40, s41
s_add_u32 s41, s41, 131072
s_add_u32 s42, s42, 256
s_cmp_lg_u32 s53, 0
s_cbranch_scc1 L_first_done
s_add_u32 s43, s43, 147456
s_add_u32 s44, s44, 1
s_branch L_K
L_first_done:
s_mov_b32 s53, 0
s_cmp_lg_u32 s36, 0
s_cbranch_scc1 L_noid
s_lshl_b32 s50, s38, 3
s_add_u32 s50, s50, 4
v_mov_b32 v232, 1
v_mov_b32 v233, 0
v_cmp_eq_u32 vcc, 0, v240
s_nop 3
s_and_saveexec_b64 s[54:55], vcc
buffer_atomic_add v232, v233, s[32:35], s50 offen sc1
s_mov_b64 exec, s[54:55]
L_noid:
s_branch L_K
L_Olast:
s_cmp_lg_u32 s86, 1
s_cbranch_scc1 L_nosig
s_cmp_lg_u32 s36, 0
s_cbranch_scc1 L_nosig
s_sub_u32 s50, s2, 8
s_lshl_b32 s50, s50, 7
s_add_u32 s50, s50, 20971552
v_mov_b32 v236, 1
v_lshlrev_b32 v237, 6, v240
v_cmp_gt_u32 vcc, 16, v240
s_nop 3
s_and_saveexec_b64 s[54:55], vcc
buffer_store_dword v236, v237, s[24:27], s50 offen sc1
s_mov_b64 exec, s[54:55]
L_nosig:
s_waitcnt lgkmcnt(0)
s_waitcnt vmcnt(16)
s_barrier
v_add_u32 v232, 147456, v240
ds_read_b128 v[0:3], v232 offset:0
ds_read_b128 v[4:7], v232 offset:1024
ds_read_b128 v[8:11], v232 offset:2048
ds_read_b128 v[12:15], v232 offset:3072
ds_read_b128 v[16:19], v232 offset:4096
ds_read_b128 v[20:23], v232 offset:5120
ds_read_b128 v[24:27], v232 offset:6144
ds_read_b128 v[28:31], v232 offset:7168
ds_read_b128 v[32:35], v232 offset:8192
ds_read_b128 v[36:39], v232 offset:9216
ds_read_b128 v[40:43], v232 offset:10240
ds_read_b128 v[44:47], v232 offset:11264
ds_read_b128 v[48:51], v232 offset:12288
ds_read_b128 v[52:55], v232 offset:13312
ds_read_b128 v[56:59], v232 offset:14336
ds_read_b128 v[60:63], v232 offset:15360
v_add_u32 v242, 65536, v229
ds_read_b64_tr_b16 v[176:177], v242 offset:49152
ds_read_b64_tr_b16 v[178:179], v242 offset:51200
s_waitcnt lgkmcnt(2)
s_waitcnt lgkmcnt(0)
v_mfma_f32_16x16x32_bf16 a[0:3], v[176:179], v[0:3], a[0:3]
ds_read_b64_tr_b16 v[180:181], v242 offset:53248
v_mfma_f32_16x16x32_bf16 a[4:7], v[176:179], v[4:7], a[4:7]
s_add_u32 m0, s37, 49152
s_add_u32 s49, s43, 640
buffer_load_dwordx4 v214, s[16:19], s49 offen lds
ds_read_b64_tr_b16 v[182:183], v242 offset:55296
v_mfma_f32_16x16x32_bf16 a[8:11], v[176:179], v[8:11], a[8:11]
ds_read_b64_tr_b16 v[184:185], v242 offset:57344
v_mfma_f32_16x16x32_bf16 a[12:15], v[176:179], v[12:15], a[12:15]
ds_read_b64_tr_b16 v[186:187], v242 offset:59392
s_waitcnt lgkmcnt(0)
v_mfma_f32_16x16x32_bf16 a[0:3], v[180:183], v[16:19], a[0:3]
ds_read_b64_tr_b16 v[188:189], v242 offset:61440
v_mfma_f32_16x16x32_bf16 a[4:7], v[180:183], v[20:23], a[4:7]
buffer_load_dwordx4 v215, s[16:19], s49 offen offset:1024 lds
ds_read_b64_tr_b16 v[190:191], v242 offset:63488
v_mfma_f32_16x16x32_bf16 a[8:11], v[180:183], v[24:27], a[8:11]
v_mfma_f32_16x16x32_bf16 a[12:15], v[180:183], v[28:31], a[12:15]
buffer_load_dwordx4 v216, s[16:19], s49 offen offset:2048 lds
buffer_load_dwordx4 v217, s[16:19], s49 offen offset:3072 lds
s_waitcnt vmcnt(16)
s_barrier
v_add_u32 v242, 131072, v229
ds_read_b64_tr_b16 v[192:193], v242 offset:0
v_mfma_f32_16x16x32_bf16 a[0:3], v[184:187], v[32:35], a[0:3]
ds_read_b64_tr_b16 v[194:195], v242 offset:2048
v_mfma_f32_16x16x32_bf16 a[4:7], v[184:187], v[36:39], a[4:7]
s_add_u32 m0, s37, 65536
s_add_u32 s48, s43, 768
buffer_load_dwordx4 v214, s[16:19], s48 offen lds
v_mfma_f32_16x16x32_bf16 a[8:11], v[184:187], v[40:43], a[8:11]
v_mfma_f32_16x16x32_bf16 a[12:15], v[184:187], v[44:47], a[12:15]
ds_read_b64_tr_b16 v[196:197], v242 offset:4096
s_waitcnt lgkmcnt(1)
v_mfma_f32_16x16x32_bf16 a[0:3], v[188:191], v[48:51], a[0:3]
ds_read_b64_tr_b16 v[198:199], v242 offset:6144
v_mfma_f32_16x16x32_bf16 a[4:7], v[188:191], v[52:55], a[4:7]
buffer_load_dwordx4 v215, s[16:19], s48 offen offset:1024 lds
v_mfma_f32_16x16x32_bf16 a[8:11], v[188:191], v[56:59], a[8:11]
v_mfma_f32_16x16x32_bf16 a[12:15], v[188:191], v[60:63], a[12:15]
ds_read_b64_tr_b16 v[200:201], v242 offset:8192
v_mfma_f32_16x16x32_bf16 a[16:19], v[192:195], v[0:3], a[16:19]
ds_read_b64_tr_b16 v[202:203], v242 offset:10240
v_mfma_f32_16x16x32_bf16 a[20:23], v[192:195], v[4:7], a[20:23]
buffer_load_dwordx4 v216, s[16:19], s48 offen offset:2048 lds
v_accvgpr_read_b32 v120, a0
v_accvgpr_read_b32 v121, a1
v_mfma_f32_16x16x32_bf16 a[24:27], v[192:195], v[8:11], a[24:27]
v_accvgpr_read_b32 v122, a2
v_accvgpr_read_b32 v123, a3
v_mfma_f32_16x16x32_bf16 a[28:31], v[192:195], v[12:15], a[28:31]
ds_read_b64_tr_b16 v[204:205], v242 offset:12288
s_waitcnt lgkmcnt(1)
v_accvgpr_read_b32 v124, a4
v_accvgpr_read_b32 v125, a5
v_mfma_f32_16x16x32_bf16 a[16:19], v[196:199], v[16:19], a[16:19]
ds_read_b64_tr_b16 v[206:207], v242 offset:14336
v_accvgpr_read_b32 v126, a6
v_accvgpr_read_b32 v127, a7
v_mfma_f32_16x16x32_bf16 a[20:23], v[196:199], v[20:23], a[20:23]
buffer_load_dwordx4 v217, s[16:19], s48 offen offset:3072 lds
v_cvt_pk_bf16_f32 v64, v120, v121
v_cvt_pk_bf16_f32 v65, v122, v123
v_mfma_f32_16x16x32_bf16 a[24:27], v[196:199], v[24:27], a[24:27]
v_cvt_pk_bf16_f32 v66, v124, v125
v_cvt_pk_bf16_f32 v67, v126, v127
v_mfma_f32_16x16x32_bf16 a[28:31], v[196:199], v[28:31], a[28:31]
s_waitcnt vmcnt(16)
s_barrier
v_mov_b32 v242, v229
ds_read_b64_tr_b16 v[160:161], v242 offset:0
v_accvgpr_read_b32 v120, a8
v_mfma_f32_16x16x32_bf16 a[16:19], v[200:203], v[32:35], a[16:19]
ds_read_b64_tr_b16 v[162:163], v242 offset:2048
v_accvgpr_read_b32 v121, a9
v_accvgpr_read_b32 v122, a10
v_mfma_f32_16x16x32_bf16 a[20:23], v[200:203], v[36:39], a[20:23]
s_add_u32 m0, s37, 81920
s_add_u32 s49, s43, 896
buffer_load_dwordx4 v214, s[16:19], s49 offen lds
v_accvgpr_read_b32 v123, a11
v_accvgpr_read_b32 v124, a12
v_mfma_f32_16x16x32_bf16 a[24:27], v[200:203], v[40:43], a[24:27]
v_accvgpr_read_b32 v125, a13
v_accvgpr_read_b32 v126, a14
v_mfma_f32_16x16x32_bf16 a[28:31], v[200:203], v[44:47], a[28:31]
ds_read_b64_tr_b16 v[164:165], v242 offset:4096
s_waitcnt lgkmcnt(1)
v_accvgpr_read_b32 v127, a15
v_cvt_pk_bf16_f32 v68, v120, v121
v_mfma_f32_16x16x32_bf16 a[16:19], v[204:207], v[48:51], a[16:19]
ds_read_b64_tr_b16 v[166:167], v242 offset:6144
v_cvt_pk_bf16_f32 v69, v122, v123
v_cvt_pk_bf16_f32 v70, v124, v125
v_mfma_f32_16x16x32_bf16 a[20:23], v[204:207], v[52:55], a[20:23]
buffer_load_dwordx4 v215, s[16:19], s49 offen offset:1024 lds
v_cvt_pk_bf16_f32 v71, v126, v127
v_mfma_f32_16x16x32_bf16 a[24:27], v[204:207], v[56:59], a[24:27]
v_mfma_f32_16x16x32_bf16 a[28:31], v[204:207], v[60:63], a[28:31]
ds_read_b64_tr_b16 v[168:169], v242 offset:8192
v_mfma_f32_16x16x32_bf16 a[32:35], v[160:163], v[0:3], a[32:35]
ds_read_b64_tr_b16 v[170:171], v242 offset:10240
v_mfma_f32_16x16x32_bf16 a[36:39], v[160:163], v[4:7], a[36:39]
buffer_load_dwordx4 v216, s[16:19], s49 offen offset:2048 lds
v_accvgpr_read_b32 v120, a16
v_accvgpr_read_b32 v121, a17
v_mfma_f32_16x16x32_bf16 a[40:43], v[160:163], v[8:11], a[40:43]
v_accvgpr_read_b32 v122, a18
v_accvgpr_read_b32 v123, a19
v_mfma_f32_16x16x32_bf16 a[44:47], v[160:163], v[12:15], a[44:47]
ds_read_b64_tr_b16 v[172:173], v242 offset:12288
s_waitcnt lgkmcnt(1)
v_accvgpr_read_b32 v124, a20
v_accvgpr_read_b32 v125, a21
v_mfma_f32_16x16x32_bf16 a[32:35], v[164:167], v[16:19], a[32:35]
ds_read_b64_tr_b16 v[174:175], v242 offset:14336
v_accvgpr_read_b32 v126, a22
v_accvgpr_read_b32 v127, a23
v_mfma_f32_16x16x32_bf16 a[36:39], v[164:167], v[20:23], a[36:39]
buffer_load_dwordx4 v217, s[16:19], s49 offen offset:3072 lds
v_cvt_pk_bf16_f32 v72, v120, v121
v_cvt_pk_bf16_f32 v73, v122, v123
v_mfma_f32_16x16x32_bf16 a[40:43], v[164:167], v[24:27], a[40:43]
v_cvt_pk_bf16_f32 v74, v124, v125
v_cvt_pk_bf16_f32 v75, v126, v127
v_mfma_f32_16x16x32_bf16 a[44:47], v[164:167], v[28:31], a[44:47]
s_waitcnt vmcnt(16)
s_barrier
ds_read_b64_tr_b16 v[176:177], v242 offset:16384
v_accvgpr_read_b32 v120, a24
v_mfma_f32_16x16x32_bf16 a[32:35], v[168:171], v[32:35], a[32:35]
ds_read_b64_tr_b16 v[178:179], v242 offset:18432
v_accvgpr_read_b32 v121, a25
v_accvgpr_read_b32 v122, a26
v_mfma_f32_16x16x32_bf16 a[36:39], v[168:171], v[36:39], a[36:39]
s_add_u32 m0, s37, 98304
s_add_u32 s48, s43, 1024
buffer_load_dwordx4 v214, s[16:19], s48 offen lds
v_accvgpr_read_b32 v123, a27
v_accvgpr_read_b32 v124, a28
v_mfma_f32_16x16x32_bf16 a[40:43], v[168:171], v[40:43], a[40:43]
v_accvgpr_read_b32 v125, a29
v_accvgpr_read_b32 v126, a30
v_mfma_f32_16x16x32_bf16 a[44:47], v[168:171], v[44:47], a[44:47]
ds_read_b64_tr_b16 v[180:181], v242 offset:20480
s_waitcnt lgkmcnt(1)
v_accvgpr_read_b32 v127, a31
v_cvt_pk_bf16_f32 v76, v120, v121
v_mfma_f32_16x16x32_bf16 a[32:35], v[172:175], v[48:51], a[32:35]
ds_read_b64_tr_b16 v[182:183], v242 offset:22528
v_cvt_pk_bf16_f32 v77, v122, v123
v_cvt_pk_bf16_f32 v78, v124, v125
v_mfma_f32_16x16x32_bf16 a[36:39], v[172:175], v[52:55], a[36:39]
buffer_load_dwordx4 v215, s[16:19], s48 offen offset:1024 lds
v_cvt_pk_bf16_f32 v79, v126, v127
v_mfma_f32_16x16x32_bf16 a[40:43], v[172:175], v[56:59], a[40:43]
v_mfma_f32_16x16x32_bf16 a[44:47], v[172:175], v[60:63], a[44:47]
ds_read_b64_tr_b16 v[184:185], v242 offset:24576
v_mfma_f32_16x16x32_bf16 a[48:51], v[176:179], v[0:3], a[48:51]
ds_read_b64_tr_b16 v[186:187], v242 offset:26624
v_mfma_f32_16x16x32_bf16 a[52:55], v[176:179], v[4:7], a[52:55]
buffer_load_dwordx4 v216, s[16:19], s48 offen offset:2048 lds
v_accvgpr_read_b32 v120, a32
v_accvgpr_read_b32 v121, a33
v_mfma_f32_16x16x32_bf16 a[56:59], v[176:179], v[8:11], a[56:59]
v_accvgpr_read_b32 v122, a34
v_accvgpr_read_b32 v123, a35
v_mfma_f32_16x16x32_bf16 a[60:63], v[176:179], v[12:15], a[60:63]
ds_read_b64_tr_b16 v[188:189], v242 offset:28672
s_waitcnt lgkmcnt(1)
v_accvgpr_read_b32 v124, a36
v_accvgpr_read_b32 v125, a37
v_mfma_f32_16x16x32_bf16 a[48:51], v[180:183], v[16:19], a[48:51]
ds_read_b64_tr_b16 v[190:191], v242 offset:30720
v_accvgpr_read_b32 v126, a38
v_accvgpr_read_b32 v127, a39
v_mfma_f32_16x16x32_bf16 a[52:55], v[180:183], v[20:23], a[52:55]
buffer_load_dwordx4 v217, s[16:19], s48 offen offset:3072 lds
v_cvt_pk_bf16_f32 v80, v120, v121
v_cvt_pk_bf16_f32 v81, v122, v123
v_mfma_f32_16x16x32_bf16 a[56:59], v[180:183], v[24:27], a[56:59]
v_cvt_pk_bf16_f32 v82, v124, v125
v_cvt_pk_bf16_f32 v83, v126, v127
v_mfma_f32_16x16x32_bf16 a[60:63], v[180:183], v[28:31], a[60:63]
s_waitcnt vmcnt(16)
s_barrier
ds_read_b64_tr_b16 v[192:193], v242 offset:32768
v_accvgpr_read_b32 v120, a40
v_mfma_f32_16x16x32_bf16 a[48:51], v[184:187], v[32:35], a[48:51]
ds_read_b64_tr_b16 v[194:195], v242 offset:34816
v_accvgpr_read_b32 v121, a41
v_accvgpr_read_b32 v122, a42
v_mfma_f32_16x16x32_bf16 a[52:55], v[184:187], v[36:39], a[52:55]
v_accvgpr_read_b32 v123, a43
v_accvgpr_read_b32 v124, a44
v_mfma_f32_16x16x32_bf16 a[56:59], v[184:187], v[40:43], a[56:59]
v_accvgpr_read_b32 v125, a45
v_accvgpr_read_b32 v126, a46
v_mfma_f32_16x16x32_bf16 a[60:63], v[184:187], v[44:47], a[60:63]
ds_read_b64_tr_b16 v[196:197], v242 offset:36864
s_waitcnt lgkmcnt(1)
v_accvgpr_read_b32 v127, a47
v_cvt_pk_bf16_f32 v84, v120, v121
v_mfma_f32_16x16x32_bf16 a[48:51], v[188:191], v[48:51], a[48:51]
ds_read_b64_tr_b16 v[198:199], v242 offset:38912
v_cvt_pk_bf16_f32 v85, v122, v123
v_cvt_pk_bf16_f32 v86, v124, v125
v_mfma_f32_16x16x32_bf16 a[52:55], v[188:191], v[52:55], a[52:55]
v_cvt_pk_bf16_f32 v87, v126, v127
v_mfma_f32_16x16x32_bf16 a[56:59], v[188:191], v[56:59], a[56:59]
v_mfma_f32_16x16x32_bf16 a[60:63], v[188:191], v[60:63], a[60:63]
ds_read_b64_tr_b16 v[200:201], v242 offset:40960
v_mfma_f32_16x16x32_bf16 a[64:67], v[192:195], v[0:3], a[64:67]
ds_read_b64_tr_b16 v[202:203], v242 offset:43008
v_mfma_f32_16x16x32_bf16 a[68:71], v[192:195], v[4:7], a[68:71]
v_accvgpr_read_b32 v120, a48
v_accvgpr_read_b32 v121, a49
v_mfma_f32_16x16x32_bf16 a[72:75], v[192:195], v[8:11], a[72:75]
v_accvgpr_read_b32 v122, a50
v_accvgpr_read_b32 v123, a51
v_mfma_f32_16x16x32_bf16 a[76:79], v[192:195], v[12:15], a[76:79]
ds_read_b64_tr_b16 v[204:205], v242 offset:45056
s_waitcnt lgkmcnt(1)
v_accvgpr_read_b32 v124, a52
v_accvgpr_read_b32 v125, a53
v_mfma_f32_16x16x32_bf16 a[64:67], v[196:199], v[16:19], a[64:67]
ds_read_b64_tr_b16 v[206:207], v242 offset:47104
v_accvgpr_read_b32 v126, a54
v_accvgpr_read_b32 v127, a55
v_mfma_f32_16x16x32_bf16 a[68:71], v[196:199], v[20:23], a[68:71]
v_cvt_pk_bf16_f32 v88, v120, v121
v_cvt_pk_bf16_f32 v89, v122, v123
v_mfma_f32_16x16x32_bf16 a[72:75], v[196:199], v[24:27], a[72:75]
v_cvt_pk_bf16_f32 v90, v124, v125
v_cvt_pk_bf16_f32 v91, v126, v127
v_mfma_f32_16x16x32_bf16 a[76:79], v[196:199], v[28:31], a[76:79]
s_waitcnt vmcnt(12)
s_barrier
ds_read_b64_tr_b16 v[160:161], v242 offset:49152
v_accvgpr_read_b32 v120, a56
v_mfma_f32_16x16x32_bf16 a[64:67], v[200:203], v[32:35], a[64:67]
ds_read_b64_tr_b16 v[162:163], v242 offset:51200
v_accvgpr_read_b32 v121, a57
v_accvgpr_read_b32 v122, a58
v_mfma_f32_16x16x32_bf16 a[68:71], v[200:203], v[36:39], a[68:71]
v_accvgpr_read_b32 v123, a59
v_accvgpr_read_b32 v124, a60
v_mfma_f32_16x16x32_bf16 a[72:75], v[200:203], v[40:43], a[72:75]
v_accvgpr_read_b32 v125, a61
v_accvgpr_read_b32 v126, a62
v_mfma_f32_16x16x32_bf16 a[76:79], v[200:203], v[44:47], a[76:79]
ds_read_b64_tr_b16 v[164:165], v242 offset:53248
s_waitcnt lgkmcnt(1)
v_accvgpr_read_b32 v127, a63
v_cvt_pk_bf16_f32 v92, v120, v121
v_mfma_f32_16x16x32_bf16 a[64:67], v[204:207], v[48:51], a[64:67]
ds_read_b64_tr_b16 v[166:167], v242 offset:55296
v_cvt_pk_bf16_f32 v93, v122, v123
v_cvt_pk_bf16_f32 v94, v124, v125
v_mfma_f32_16x16x32_bf16 a[68:71], v[204:207], v[52:55], a[68:71]
v_cvt_pk_bf16_f32 v95, v126, v127
v_mfma_f32_16x16x32_bf16 a[72:75], v[204:207], v[56:59], a[72:75]
v_mfma_f32_16x16x32_bf16 a[76:79], v[204:207], v[60:63], a[76:79]
ds_read_b64_tr_b16 v[168:169], v242 offset:57344
v_mfma_f32_16x16x32_bf16 a[80:83], v[160:163], v[0:3], a[80:83]
ds_read_b64_tr_b16 v[170:171], v242 offset:59392
v_mfma_f32_16x16x32_bf16 a[84:87], v[160:163], v[4:7], a[84:87]
v_accvgpr_read_b32 v120, a64
v_accvgpr_read_b32 v121, a65
v_mfma_f32_16x16x32_bf16 a[88:91], v[160:163], v[8:11], a[88:91]
v_accvgpr_read_b32 v122, a66
v_accvgpr_read_b32 v123, a67
v_mfma_f32_16x16x32_bf16 a[92:95], v[160:163], v[12:15], a[92:95]
ds_read_b64_tr_b16 v[172:173], v242 offset:61440
s_waitcnt lgkmcnt(1)
v_accvgpr_read_b32 v124, a68
v_accvgpr_read_b32 v125, a69
v_mfma_f32_16x16x32_bf16 a[80:83], v[164:167], v[16:19], a[80:83]
ds_read_b64_tr_b16 v[174:175], v242 offset:63488
v_accvgpr_read_b32 v126, a70
v_accvgpr_read_b32 v127, a71
v_mfma_f32_16x16x32_bf16 a[84:87], v[164:167], v[20:23], a[84:87]
v_cvt_pk_bf16_f32 v96, v120, v121
v_cvt_pk_bf16_f32 v97, v122, v123
v_mfma_f32_16x16x32_bf16 a[88:91], v[164:167], v[24:27], a[88:91]
v_cvt_pk_bf16_f32 v98, v124, v125
v_cvt_pk_bf16_f32 v99, v126, v127
v_mfma_f32_16x16x32_bf16 a[92:95], v[164:167], v[28:31], a[92:95]
s_waitcnt vmcnt(8)
s_barrier
v_add_u32 v242, 65536, v229
ds_read_b64_tr_b16 v[176:177], v242 offset:0
v_accvgpr_read_b32 v120, a72
v_mfma_f32_16x16x32_bf16 a[80:83], v[168:171], v[32:35], a[80:83]
ds_read_b64_tr_b16 v[178:179], v242 offset:2048
v_accvgpr_read_b32 v121, a73
v_accvgpr_read_b32 v122, a74
v_mfma_f32_16x16x32_bf16 a[84:87], v[168:171], v[36:39], a[84:87]
v_accvgpr_read_b32 v123, a75
v_accvgpr_read_b32 v124, a76
v_mfma_f32_16x16x32_bf16 a[88:91], v[168:171], v[40:43], a[88:91]
v_accvgpr_read_b32 v125, a77
v_accvgpr_read_b32 v126, a78
v_mfma_f32_16x16x32_bf16 a[92:95], v[168:171], v[44:47], a[92:95]
ds_read_b64_tr_b16 v[180:181], v242 offset:4096
s_waitcnt lgkmcnt(1)
v_accvgpr_read_b32 v127, a79
v_cvt_pk_bf16_f32 v100, v120, v121
v_mfma_f32_16x16x32_bf16 a[80:83], v[172:175], v[48:51], a[80:83]
ds_read_b64_tr_b16 v[182:183], v242 offset:6144
v_cvt_pk_bf16_f32 v101, v122, v123
v_cvt_pk_bf16_f32 v102, v124, v125
v_mfma_f32_16x16x32_bf16 a[84:87], v[172:175], v[52:55], a[84:87]
v_cvt_pk_bf16_f32 v103, v126, v127
v_mfma_f32_16x16x32_bf16 a[88:91], v[172:175], v[56:59], a[88:91]
v_mfma_f32_16x16x32_bf16 a[92:95], v[172:175], v[60:63], a[92:95]
ds_read_b64_tr_b16 v[184:185], v242 offset:8192
v_mfma_f32_16x16x32_bf16 a[96:99], v[176:179], v[0:3], a[96:99]
ds_read_b64_tr_b16 v[186:187], v242 offset:10240
v_mfma_f32_16x16x32_bf16 a[100:103], v[176:179], v[4:7], a[100:103]
v_accvgpr_read_b32 v120, a80
v_accvgpr_read_b32 v121, a81
v_mfma_f32_16x16x32_bf16 a[104:107], v[176:179], v[8:11], a[104:107]
v_accvgpr_read_b32 v122, a82
v_accvgpr_read_b32 v123, a83
v_mfma_f32_16x16x32_bf16 a[108:111], v[176:179], v[12:15], a[108:111]
ds_read_b64_tr_b16 v[188:189], v242 offset:12288
s_waitcnt lgkmcnt(1)
v_accvgpr_read_b32 v124, a84
v_accvgpr_read_b32 v125, a85
v_mfma_f32_16x16x32_bf16 a[96:99], v[180:183], v[16:19], a[96:99]
ds_read_b64_tr_b16 v[190:191], v242 offset:14336
v_accvgpr_read_b32 v126, a86
v_accvgpr_read_b32 v127, a87
v_mfma_f32_16x16x32_bf16 a[100:103], v[180:183], v[20:23], a[100:103]
v_cvt_pk_bf16_f32 v104, v120, v121
v_cvt_pk_bf16_f32 v105, v122, v123
v_mfma_f32_16x16x32_bf16 a[104:107], v[180:183], v[24:27], a[104:107]
v_cvt_pk_bf16_f32 v106, v124, v125
v_cvt_pk_bf16_f32 v107, v126, v127
v_mfma_f32_16x16x32_bf16 a[108:111], v[180:183], v[28:31], a[108:111]
s_waitcnt vmcnt(4)
s_barrier
ds_read_b64_tr_b16 v[192:193], v242 offset:16384
v_accvgpr_read_b32 v120, a88
v_mfma_f32_16x16x32_bf16 a[96:99], v[184:187], v[32:35], a[96:99]
ds_read_b64_tr_b16 v[194:195], v242 offset:18432
v_accvgpr_read_b32 v121, a89
v_accvgpr_read_b32 v122, a90
v_mfma_f32_16x16x32_bf16 a[100:103], v[184:187], v[36:39], a[100:103]
v_accvgpr_read_b32 v123, a91
v_accvgpr_read_b32 v124, a92
v_mfma_f32_16x16x32_bf16 a[104:107], v[184:187], v[40:43], a[104:107]
v_accvgpr_read_b32 v125, a93
v_accvgpr_read_b32 v126, a94
v_mfma_f32_16x16x32_bf16 a[108:111], v[184:187], v[44:47], a[108:111]
ds_read_b64_tr_b16 v[196:197], v242 offset:20480
s_waitcnt lgkmcnt(1)
v_accvgpr_read_b32 v127, a95
v_cvt_pk_bf16_f32 v108, v120, v121
v_mfma_f32_16x16x32_bf16 a[96:99], v[188:191], v[48:51], a[96:99]
ds_read_b64_tr_b16 v[198:199], v242 offset:22528
v_cvt_pk_bf16_f32 v109, v122, v123
v_cvt_pk_bf16_f32 v110, v124, v125
v_mfma_f32_16x16x32_bf16 a[100:103], v[188:191], v[52:55], a[100:103]
v_cvt_pk_bf16_f32 v111, v126, v127
v_mfma_f32_16x16x32_bf16 a[104:107], v[188:191], v[56:59], a[104:107]
v_mfma_f32_16x16x32_bf16 a[108:111], v[188:191], v[60:63], a[108:111]
ds_read_b64_tr_b16 v[200:201], v242 offset:24576
v_mfma_f32_16x16x32_bf16 a[112:115], v[192:195], v[0:3], a[112:115]
ds_read_b64_tr_b16 v[202:203], v242 offset:26624
v_mfma_f32_16x16x32_bf16 a[116:119], v[192:195], v[4:7], a[116:119]
v_accvgpr_read_b32 v120, a96
v_accvgpr_read_b32 v121, a97
v_mfma_f32_16x16x32_bf16 a[120:123], v[192:195], v[8:11], a[120:123]
v_accvgpr_read_b32 v122, a98
v_accvgpr_read_b32 v123, a99
v_mfma_f32_16x16x32_bf16 a[124:127], v[192:195], v[12:15], a[124:127]
ds_read_b64_tr_b16 v[204:205], v242 offset:28672
s_waitcnt lgkmcnt(1)
v_accvgpr_read_b32 v124, a100
v_accvgpr_read_b32 v125, a101
v_mfma_f32_16x16x32_bf16 a[112:115], v[196:199], v[16:19], a[112:115]
ds_read_b64_tr_b16 v[206:207], v242 offset:30720
v_accvgpr_read_b32 v126, a102
v_accvgpr_read_b32 v127, a103
v_mfma_f32_16x16x32_bf16 a[116:119], v[196:199], v[20:23], a[116:119]
v_cvt_pk_bf16_f32 v112, v120, v121
v_cvt_pk_bf16_f32 v113, v122, v123
v_mfma_f32_16x16x32_bf16 a[120:123], v[196:199], v[24:27], a[120:123]
v_cvt_pk_bf16_f32 v114, v124, v125
v_cvt_pk_bf16_f32 v115, v126, v127
v_mfma_f32_16x16x32_bf16 a[124:127], v[196:199], v[28:31], a[124:127]
s_waitcnt vmcnt(0)
s_barrier
ds_read_b64_tr_b16 v[160:161], v242 offset:32768
v_accvgpr_read_b32 v120, a104
v_mfma_f32_16x16x32_bf16 a[112:115], v[200:203], v[32:35], a[112:115]
ds_read_b64_tr_b16 v[162:163], v242 offset:34816
v_accvgpr_read_b32 v121, a105
v_accvgpr_read_b32 v122, a106
v_mfma_f32_16x16x32_bf16 a[116:119], v[200:203], v[36:39], a[116:119]
v_accvgpr_read_b32 v123, a107
v_accvgpr_read_b32 v124, a108
v_mfma_f32_16x16x32_bf16 a[120:123], v[200:203], v[40:43], a[120:123]
v_accvgpr_read_b32 v125, a109
v_accvgpr_read_b32 v126, a110
v_mfma_f32_16x16x32_bf16 a[124:127], v[200:203], v[44:47], a[124:127]
ds_read_b64_tr_b16 v[164:165], v242 offset:36864
s_waitcnt lgkmcnt(1)
v_accvgpr_read_b32 v127, a111
v_cvt_pk_bf16_f32 v116, v120, v121
v_mfma_f32_16x16x32_bf16 a[112:115], v[204:207], v[48:51], a[112:115]
ds_read_b64_tr_b16 v[166:167], v242 offset:38912
v_cvt_pk_bf16_f32 v117, v122, v123
v_cvt_pk_bf16_f32 v118, v124, v125
v_mfma_f32_16x16x32_bf16 a[116:119], v[204:207], v[52:55], a[116:119]
v_cvt_pk_bf16_f32 v119, v126, v127
v_mfma_f32_16x16x32_bf16 a[120:123], v[204:207], v[56:59], a[120:123]
v_mfma_f32_16x16x32_bf16 a[124:127], v[204:207], v[60:63], a[124:127]
ds_read_b64_tr_b16 v[168:169], v242 offset:40960
v_mfma_f32_16x16x32_bf16 a[128:131], v[160:163], v[0:3], a[128:131]
ds_read_b64_tr_b16 v[170:171], v242 offset:43008
v_mfma_f32_16x16x32_bf16 a[132:135], v[160:163], v[4:7], a[132:135]
v_accvgpr_read_b32 v120, a112
v_accvgpr_read_b32 v121, a113
v_mfma_f32_16x16x32_bf16 a[136:139], v[160:163], v[8:11], a[136:139]
v_accvgpr_read_b32 v122, a114
v_accvgpr_read_b32 v123, a115
v_mfma_f32_16x16x32_bf16 a[140:143], v[160:163], v[12:15], a[140:143]
ds_read_b64_tr_b16 v[172:173], v242 offset:45056
s_waitcnt lgkmcnt(1)
v_accvgpr_read_b32 v124, a116
v_accvgpr_read_b32 v125, a117
v_mfma_f32_16x16x32_bf16 a[128:131], v[164:167], v[16:19], a[128:131]
ds_read_b64_tr_b16 v[174:175], v242 offset:47104
v_accvgpr_read_b32 v126, a118
v_accvgpr_read_b32 v127, a119
v_mfma_f32_16x16x32_bf16 a[132:135], v[164:167], v[20:23], a[132:135]
v_cvt_pk_bf16_f32 v128, v120, v121
v_cvt_pk_bf16_f32 v129, v122, v123
v_mfma_f32_16x16x32_bf16 a[136:139], v[164:167], v[24:27], a[136:139]
v_cvt_pk_bf16_f32 v130, v124, v125
v_cvt_pk_bf16_f32 v131, v126, v127
v_mfma_f32_16x16x32_bf16 a[140:143], v[164:167], v[28:31], a[140:143]
v_accvgpr_read_b32 v120, a120
v_mfma_f32_16x16x32_bf16 a[128:131], v[168:171], v[32:35], a[128:131]
v_accvgpr_read_b32 v121, a121
v_accvgpr_read_b32 v122, a122
v_mfma_f32_16x16x32_bf16 a[132:135], v[168:171], v[36:39], a[132:135]
v_accvgpr_read_b32 v123, a123
v_accvgpr_read_b32 v124, a124
v_mfma_f32_16x16x32_bf16 a[136:139], v[168:171], v[40:43], a[136:139]
v_accvgpr_read_b32 v125, a125
v_accvgpr_read_b32 v126, a126
v_mfma_f32_16x16x32_bf16 a[140:143], v[168:171], v[44:47], a[140:143]
s_waitcnt lgkmcnt(0)
v_accvgpr_read_b32 v127, a127
v_cvt_pk_bf16_f32 v132, v120, v121
v_mfma_f32_16x16x32_bf16 a[128:131], v[172:175], v[48:51], a[128:131]
v_cvt_pk_bf16_f32 v133, v122, v123
v_cvt_pk_bf16_f32 v134, v124, v125
v_mfma_f32_16x16x32_bf16 a[132:135], v[172:175], v[52:55], a[132:135]
v_cvt_pk_bf16_f32 v135, v126, v127
v_mfma_f32_16x16x32_bf16 a[136:139], v[172:175], v[56:59], a[136:139]
v_mfma_f32_16x16x32_bf16 a[140:143], v[172:175], v[60:63], a[140:143]
s_nop 7
v_accvgpr_read_b32 v120, a128
v_accvgpr_read_b32 v121, a129
v_accvgpr_read_b32 v122, a130
v_accvgpr_read_b32 v123, a131
v_accvgpr_read_b32 v124, a132
v_accvgpr_read_b32 v125, a133
v_accvgpr_read_b32 v126, a134
v_accvgpr_read_b32 v127, a135
v_cvt_pk_bf16_f32 v136, v120, v121
v_cvt_pk_bf16_f32 v137, v122, v123
v_cvt_pk_bf16_f32 v138, v124, v125
v_cvt_pk_bf16_f32 v139, v126, v127
v_accvgpr_read_b32 v120, a136
v_accvgpr_read_b32 v121, a137
v_accvgpr_read_b32 v122, a138
v_accvgpr_read_b32 v123, a139
v_accvgpr_read_b32 v124, a140
v_accvgpr_read_b32 v125, a141
v_accvgpr_read_b32 v126, a142
v_accvgpr_read_b32 v127, a143
v_cvt_pk_bf16_f32 v140, v120, v121
v_cvt_pk_bf16_f32 v141, v122, v123
v_cvt_pk_bf16_f32 v142, v124, v125
v_cvt_pk_bf16_f32 v143, v126, v127
s_cmp_eq_u32 s86, 1
s_cbranch_scc1 L_nogate
s_cmp_lg_u32 s36, 0
s_cbranch_scc1 L_gate_ok
s_lshl_b32 s48, s2, 7
s_add_u32 s48, s48, 20971552
v_mov_b32 v237, 0
s_mov_b32 s49, 0
L_gate:
buffer_load_dword v236, v237, s[24:27], s48 offen sc1
s_waitcnt vmcnt(0)
v_readfirstlane_b32 s51, v236
s_nop 3
s_cmp_eq_u32 s51, 1
s_cbranch_scc1 L_gate_ok
s_sleep 2
s_add_u32 s49, s49, 1
s_cmp_lt_u32 s49, 48
s_cbranch_scc1 L_gate
L_gate_ok:
s_barrier
L_nogate:
s_add_u32 s50, s52, 0
buffer_store_dwordx4 v[64:67], v241, s[24:27], s50 offen sc1
s_add_u32 s50, s52, 4096
buffer_store_dwordx4 v[68:71], v241, s[24:27], s50 offen sc1
s_add_u32 s50, s52, 8192
buffer_store_dwordx4 v[72:75], v241, s[24:27], s50 offen sc1
s_add_u32 s50, s52, 12288
buffer_store_dwordx4 v[76:79], v241, s[24:27], s50 offen sc1
s_add_u32 s50, s52, 16384
buffer_store_dwordx4 v[80:83], v241, s[24:27], s50 offen sc1
s_add_u32 s50, s52, 20480
buffer_store_dwordx4 v[84:87], v241, s[24:27], s50 offen sc1
s_add_u32 s50, s52, 24576
buffer_store_dwordx4 v[88:91], v241, s[24:27], s50 offen sc1
s_add_u32 s50, s52, 28672
buffer_store_dwordx4 v[92:95], v241, s[24:27], s50 offen sc1
s_add_u32 s50, s52, 32768
buffer_store_dwordx4 v[96:99], v241, s[24:27], s50 offen sc1
s_add_u32 s50, s52, 36864
buffer_store_dwordx4 v[100:103], v241, s[24:27], s50 offen sc1
s_add_u32 s50, s52, 40960
buffer_store_dwordx4 v[104:107], v241, s[24:27], s50 offen sc1
s_add_u32 s50, s52, 45056
buffer_store_dwordx4 v[108:111], v241, s[24:27], s50 offen sc1
s_add_u32 s50, s52, 49152
buffer_store_dwordx4 v[112:115], v241, s[24:27], s50 offen sc1
s_add_u32 s50, s52, 53248
buffer_store_dwordx4 v[116:119], v241, s[24:27], s50 offen sc1
s_add_u32 s50, s52, 57344
buffer_store_dwordx4 v[128:131], v241, s[24:27], s50 offen sc1
s_add_u32 s50, s52, 61440
buffer_store_dwordx4 v[132:135], v241, s[24:27], s50 offen sc1
s_add_u32 s50, s52, 65536
buffer_store_dwordx4 v[136:139], v241, s[24:27], s50 offen sc1
s_add_u32 s50, s52, 69632
buffer_store_dwordx4 v[140:143], v241, s[24:27], s50 offen sc1
s_waitcnt vmcnt(0)
s_barrier
s_lshl_b32 s48, s38, 3
s_cmp_lg_u32 s36, 0
s_cbranch_scc1 L_wait_done
v_mov_b32 v232, 1
v_mov_b32 v233, 0
s_add_u32 s48, s48, 4
s_mov_b32 s49, 0
L_chk:
v_readfirstlane_b32 s50, v245
s_nop 3
s_cmp_ge_u32 s50, 8
s_cbranch_scc1 L_chk_ok
buffer_load_dword v245, v233, s[32:35], s48 offen sc1
s_waitcnt vmcnt(0)
s_add_u32 s49, s49, 1
s_cmp_lt_u32 s49, 0x40000
s_cbranch_scc1 L_chk
L_chk_ok:
s_lshl_b32 s51, s38, 10
s_lshl_b32 s50, s39, 2
s_add_u32 s51, s51, s50
s_add_u32 s51, s51, 0x1400000
v_lshlrev_b32 v233, 3, v240
v_cmp_gt_u32 vcc, 128, v240
s_nop 3
s_and_saveexec_b64 s[54:55], vcc
buffer_store_dword v232, v233, s[24:27], s51 offen sc1
s_mov_b64 exec, s[54:55]
L_dopoll:
s_lshl_b32 s48, s2, 7
s_add_u32 s48, s48, 0x1400000
v_lshrrev_b32 v233, 2, v240
v_and_b32 v233, 31, v233
s_mov_b32 s49, 0
L_poll:
buffer_load_dword v234, v233, s[24:27], s48 offen sc1
s_waitcnt vmcnt(0)
v_cmp_eq_u32 vcc, 1, v234
s_nop 3
s_cmp_eq_u64 vcc, -1
s_cbranch_scc1 L_wait_done
s_sleep 1
s_add_u32 s49, s49, 1
s_cmp_lt_u32 s49, 0x40000
s_cbranch_scc1 L_poll
L_wait_done:
s_barrier
s_lshl_b32 s49, s38, 3
s_mul_i32 s49, s49, 73728
v_mov_b32 v112, 0x00003f80
v_mov_b32 v113, 0x3f800000
v_lshrrev_b32 v114, 4, v240
v_and_b32 v115, 15, v114
v_lshrrev_b32 v116, 4, v114
v_and_b32 v117, 1, v116
v_lshl_add_u32 v115, v117, 4, v115
v_lshrrev_b32 v116, 1, v116
s_lshl_b32 s50, s36, 1
v_add_u32 v116, s50, v116
v_and_b32 v117, 7, v115
v_xor_b32 v116, v116, v117
v_lshlrev_b32 v116, 4, v116
v_lshl_add_u32 v118, v115, 7, v116
v_lshrrev_b32 v115, 3, v114
s_lshl_b32 s50, s36, 3
v_add_u32 v115, s50, v115
v_and_b32 v116, 7, v114
v_and_b32 v117, 7, v115
v_xor_b32 v117, v117, v116
v_lshlrev_b32 v117, 4, v117
v_lshl_add_u32 v119, v115, 7, v117
v_mul_u32_u24 v115, 1152, v115
v_lshl_add_u32 v120, v116, 4, v115
s_add_u32 s48, s39, 0
s_lshl_b32 s50, s48, 2
s_add_u32 s50, s50, s36
s_lshl_b32 s50, s50, 10
s_add_u32 s50, s50, s49
buffer_load_dwordx4 v[0:3], v240, s[24:27], s50 offen sc1
s_add_u32 s50, s50, 73728
buffer_load_dwordx4 v[4:7], v240, s[24:27], s50 offen sc1
s_add_u32 s50, s50, 73728
buffer_load_dwordx4 v[8:11], v240, s[24:27], s50 offen sc1
s_add_u32 s50, s50, 73728
buffer_load_dwordx4 v[12:15], v240, s[24:27], s50 offen sc1
s_add_u32 s50, s50, 73728
buffer_load_dwordx4 v[16:19], v240, s[24:27], s50 offen sc1
s_add_u32 s50, s50, 73728
buffer_load_dwordx4 v[20:23], v240, s[24:27], s50 offen sc1
s_add_u32 s50, s50, 73728
buffer_load_dwordx4 v[24:27], v240, s[24:27], s50 offen sc1
s_add_u32 s50, s50, 73728
buffer_load_dwordx4 v[28:31], v240, s[24:27], s50 offen sc1
s_add_u32 s48, s39, 8
s_lshl_b32 s50, s48, 2
s_add_u32 s50, s50, s36
s_lshl_b32 s50, s50, 10
s_add_u32 s50, s50, s49
buffer_load_dwordx4 v[32:35], v240, s[24:27], s50 offen sc1
s_add_u32 s50, s50, 73728
buffer_load_dwordx4 v[36:39], v240, s[24:27], s50 offen sc1
s_add_u32 s50, s50, 73728
buffer_load_dwordx4 v[40:43], v240, s[24:27], s50 offen sc1
s_add_u32 s50, s50, 73728
buffer_load_dwordx4 v[44:47], v240, s[24:27], s50 offen sc1
s_add_u32 s50, s50, 73728
buffer_load_dwordx4 v[48:51], v240, s[24:27], s50 offen sc1
s_add_u32 s50, s50, 73728
buffer_load_dwordx4 v[52:55], v240, s[24:27], s50 offen sc1
s_add_u32 s50, s50, 73728
buffer_load_dwordx4 v[56:59], v240, s[24:27], s50 offen sc1
s_add_u32 s50, s50, 73728
buffer_load_dwordx4 v[60:63], v240, s[24:27], s50 offen sc1
s_cmp_ge_u32 s39, 2
s_cbranch_scc1 L_r2a
s_add_u32 s48, s39, 16
s_lshl_b32 s50, s48, 2
s_add_u32 s50, s50, s36
s_lshl_b32 s50, s50, 10
s_add_u32 s50, s50, s49
buffer_load_dwordx4 v[64:67], v240, s[24:27], s50 offen sc1
s_add_u32 s50, s50, 73728
buffer_load_dwordx4 v[68:71], v240, s[24:27], s50 offen sc1
s_add_u32 s50, s50, 73728
buffer_load_dwordx4 v[72:75], v240, s[24:27], s50 offen sc1
s_add_u32 s50, s50, 73728
buffer_load_dwordx4 v[76:79], v240, s[24:27], s50 offen sc1
s_add_u32 s50, s50, 73728
buffer_load_dwordx4 v[80:83], v240, s[24:27], s50 offen sc1
s_add_u32 s50, s50, 73728
buffer_load_dwordx4 v[84:87], v240, s[24:27], s50 offen sc1
s_add_u32 s50, s50, 73728
buffer_load_dwordx4 v[88:91], v240, s[24:27], s50 offen sc1
s_add_u32 s50, s50, 73728
buffer_load_dwordx4 v[92:95], v240, s[24:27], s50 offen sc1
L_r2a:
s_waitcnt vmcnt(8)
v_mov_b32 v100, 0
v_mov_b32 v101, 0
v_mov_b32 v102, 0
v_mov_b32 v103, 0
v_mov_b32 v104, 0
v_mov_b32 v105, 0
v_mov_b32 v106, 0
v_mov_b32 v107, 0
v_dot2c_f32_bf16 v100, v0, v112
v_dot2c_f32_bf16 v101, v0, v113
v_dot2c_f32_bf16 v102, v1, v112
v_dot2c_f32_bf16 v103, v1, v113
v_dot2c_f32_bf16 v104, v2, v112
v_dot2c_f32_bf16 v105, v2, v113
v_dot2c_f32_bf16 v106, v3, v112
v_dot2c_f32_bf16 v107, v3, v113
v_dot2c_f32_bf16 v100, v4, v112
v_dot2c_f32_bf16 v101, v4, v113
v_dot2c_f32_bf16 v102, v5, v112
v_dot2c_f32_bf16 v103, v5, v113
v_dot2c_f32_bf16 v104, v6, v112
v_dot2c_f32_bf16 v105, v6, v113
v_dot2c_f32_bf16 v106, v7, v112
v_dot2c_f32_bf16 v107, v7, v113
v_dot2c_f32_bf16 v100, v8, v112
v_dot2c_f32_bf16 v101, v8, v113
v_dot2c_f32_bf16 v102, v9, v112
v_dot2c_f32_bf16 v103, v9, v113
v_dot2c_f32_bf16 v104, v10, v112
v_dot2c_f32_bf16 v105, v10, v113
v_dot2c_f32_bf16 v106, v11, v112
v_dot2c_f32_bf16 v107, v11, v113
v_dot2c_f32_bf16 v100, v12, v112
v_dot2c_f32_bf16 v101, v12, v113
v_dot2c_f32_bf16 v102, v13, v112
v_dot2c_f32_bf16 v103, v13, v113
v_dot2c_f32_bf16 v104, v14, v112
v_dot2c_f32_bf16 v105, v14, v113
v_dot2c_f32_bf16 v106, v15, v112
v_dot2c_f32_bf16 v107, v15, v113
v_dot2c_f32_bf16 v100, v16, v112
v_dot2c_f32_bf16 v101, v16, v113
v_dot2c_f32_bf16 v102, v17, v112
v_dot2c_f32_bf16 v103, v17, v113
v_dot2c_f32_bf16 v104, v18, v112
v_dot2c_f32_bf16 v105, v18, v113
v_dot2c_f32_bf16 v106, v19, v112
v_dot2c_f32_bf16 v107, v19, v113
v_dot2c_f32_bf16 v100, v20, v112
v_dot2c_f32_bf16 v101, v20, v113
v_dot2c_f32_bf16 v102, v21, v112
v_dot2c_f32_bf16 v103, v21, v113
v_dot2c_f32_bf16 v104, v22, v112
v_dot2c_f32_bf16 v105, v22, v113
v_dot2c_f32_bf16 v106, v23, v112
v_dot2c_f32_bf16 v107, v23, v113
v_dot2c_f32_bf16 v100, v24, v112
v_dot2c_f32_bf16 v101, v24, v113
v_dot2c_f32_bf16 v102, v25, v112
v_dot2c_f32_bf16 v103, v25, v113
v_dot2c_f32_bf16 v104, v26, v112
v_dot2c_f32_bf16 v105, v26, v113
v_dot2c_f32_bf16 v106, v27, v112
v_dot2c_f32_bf16 v107, v27, v113
v_dot2c_f32_bf16 v100, v28, v112
v_dot2c_f32_bf16 v101, v28, v113
v_dot2c_f32_bf16 v102, v29, v112
v_dot2c_f32_bf16 v103, v29, v113
v_dot2c_f32_bf16 v104, v30, v112
v_dot2c_f32_bf16 v105, v30, v113
v_dot2c_f32_bf16 v106, v31, v112
v_dot2c_f32_bf16 v107, v31, v113
s_nop 2
v_cvt_pk_bf16_f32 v124, v100, v101
v_cvt_pk_bf16_f32 v125, v102, v103
v_cvt_pk_bf16_f32 v126, v104, v105
v_cvt_pk_bf16_f32 v127, v106, v107
s_nop 0
v_permlane16_swap_b32 v124, v126
v_permlane16_swap_b32 v125, v127
ds_write_b128 v118, v[124:127] offset:0
s_waitcnt vmcnt(0)
v_mov_b32 v100, 0
v_mov_b32 v101, 0
v_mov_b32 v102, 0
v_mov_b32 v103, 0
v_mov_b32 v104, 0
v_mov_b32 v105, 0
v_mov_b32 v106, 0
v_mov_b32 v107, 0
v_dot2c_f32_bf16 v100, v32, v112
v_dot2c_f32_bf16 v101, v32, v113
v_dot2c_f32_bf16 v102, v33, v112
v_dot2c_f32_bf16 v103, v33, v113
v_dot2c_f32_bf16 v104, v34, v112
v_dot2c_f32_bf16 v105, v34, v113
v_dot2c_f32_bf16 v106, v35, v112
v_dot2c_f32_bf16 v107, v35, v113
v_dot2c_f32_bf16 v100, v36, v112
v_dot2c_f32_bf16 v101, v36, v113
v_dot2c_f32_bf16 v102, v37, v112
v_dot2c_f32_bf16 v103, v37, v113
v_dot2c_f32_bf16 v104, v38, v112
v_dot2c_f32_bf16 v105, v38, v113
v_dot2c_f32_bf16 v106, v39, v112
v_dot2c_f32_bf16 v107, v39, v113
v_dot2c_f32_bf16 v100, v40, v112
v_dot2c_f32_bf16 v101, v40, v113
v_dot2c_f32_bf16 v102, v41, v112
v_dot2c_f32_bf16 v103, v41, v113
v_dot2c_f32_bf16 v104, v42, v112
v_dot2c_f32_bf16 v105, v42, v113
v_dot2c_f32_bf16 v106, v43, v112
v_dot2c_f32_bf16 v107, v43, v113
v_dot2c_f32_bf16 v100, v44, v112
v_dot2c_f32_bf16 v101, v44, v113
v_dot2c_f32_bf16 v102, v45, v112
v_dot2c_f32_bf16 v103, v45, v113
v_dot2c_f32_bf16 v104, v46, v112
v_dot2c_f32_bf16 v105, v46, v113
v_dot2c_f32_bf16 v106, v47, v112
v_dot2c_f32_bf16 v107, v47, v113
v_dot2c_f32_bf16 v100, v48, v112
v_dot2c_f32_bf16 v101, v48, v113
v_dot2c_f32_bf16 v102, v49, v112
v_dot2c_f32_bf16 v103, v49, v113
v_dot2c_f32_bf16 v104, v50, v112
v_dot2c_f32_bf16 v105, v50, v113
v_dot2c_f32_bf16 v106, v51, v112
v_dot2c_f32_bf16 v107, v51, v113
v_dot2c_f32_bf16 v100, v52, v112
v_dot2c_f32_bf16 v101, v52, v113
v_dot2c_f32_bf16 v102, v53, v112
v_dot2c_f32_bf16 v103, v53, v113
v_dot2c_f32_bf16 v104, v54, v112
v_dot2c_f32_bf16 v105, v54, v113
v_dot2c_f32_bf16 v106, v55, v112
v_dot2c_f32_bf16 v107, v55, v113
v_dot2c_f32_bf16 v100, v56, v112
v_dot2c_f32_bf16 v101, v56, v113
v_dot2c_f32_bf16 v102, v57, v112
v_dot2c_f32_bf16 v103, v57, v113
v_dot2c_f32_bf16 v104, v58, v112
v_dot2c_f32_bf16 v105, v58, v113
v_dot2c_f32_bf16 v106, v59, v112
v_dot2c_f32_bf16 v107, v59, v113
v_dot2c_f32_bf16 v100, v60, v112
v_dot2c_f32_bf16 v101, v60, v113
v_dot2c_f32_bf16 v102, v61, v112
v_dot2c_f32_bf16 v103, v61, v113
v_dot2c_f32_bf16 v104, v62, v112
v_dot2c_f32_bf16 v105, v62, v113
v_dot2c_f32_bf16 v106, v63, v112
v_dot2c_f32_bf16 v107, v63, v113
s_nop 2
v_cvt_pk_bf16_f32 v124, v100, v101
v_cvt_pk_bf16_f32 v125, v102, v103
v_cvt_pk_bf16_f32 v126, v104, v105
v_cvt_pk_bf16_f32 v127, v106, v107
s_nop 0
v_permlane16_swap_b32 v124, v126
v_permlane16_swap_b32 v125, v127
ds_write_b128 v118, v[124:127] offset:4096
s_cmp_ge_u32 s39, 2
s_cbranch_scc1 L_r2b
v_mov_b32 v100, 0
v_mov_b32 v101, 0
v_mov_b32 v102, 0
v_mov_b32 v103, 0
v_mov_b32 v104, 0
v_mov_b32 v105, 0
v_mov_b32 v106, 0
v_mov_b32 v107, 0
v_dot2c_f32_bf16 v100, v64, v112
v_dot2c_f32_bf16 v101, v64, v113
v_dot2c_f32_bf16 v102, v65, v112
v_dot2c_f32_bf16 v103, v65, v113
v_dot2c_f32_bf16 v104, v66, v112
v_dot2c_f32_bf16 v105, v66, v113
v_dot2c_f32_bf16 v106, v67, v112
v_dot2c_f32_bf16 v107, v67, v113
v_dot2c_f32_bf16 v100, v68, v112
v_dot2c_f32_bf16 v101, v68, v113
v_dot2c_f32_bf16 v102, v69, v112
v_dot2c_f32_bf16 v103, v69, v113
v_dot2c_f32_bf16 v104, v70, v112
v_dot2c_f32_bf16 v105, v70, v113
v_dot2c_f32_bf16 v106, v71, v112
v_dot2c_f32_bf16 v107, v71, v113
v_dot2c_f32_bf16 v100, v72, v112
v_dot2c_f32_bf16 v101, v72, v113
v_dot2c_f32_bf16 v102, v73, v112
v_dot2c_f32_bf16 v103, v73, v113
v_dot2c_f32_bf16 v104, v74, v112
v_dot2c_f32_bf16 v105, v74, v113
v_dot2c_f32_bf16 v106, v75, v112
v_dot2c_f32_bf16 v107, v75, v113
v_dot2c_f32_bf16 v100, v76, v112
v_dot2c_f32_bf16 v101, v76, v113
v_dot2c_f32_bf16 v102, v77, v112
v_dot2c_f32_bf16 v103, v77, v113
v_dot2c_f32_bf16 v104, v78, v112
v_dot2c_f32_bf16 v105, v78, v113
v_dot2c_f32_bf16 v106, v79, v112
v_dot2c_f32_bf16 v107, v79, v113
v_dot2c_f32_bf16 v100, v80, v112
v_dot2c_f32_bf16 v101, v80, v113
v_dot2c_f32_bf16 v102, v81, v112
v_dot2c_f32_bf16 v103, v81, v113
v_dot2c_f32_bf16 v104, v82, v112
v_dot2c_f32_bf16 v105, v82, v113
v_dot2c_f32_bf16 v106, v83, v112
v_dot2c_f32_bf16 v107, v83, v113
v_dot2c_f32_bf16 v100, v84, v112
v_dot2c_f32_bf16 v101, v84, v113
v_dot2c_f32_bf16 v102, v85, v112
v_dot2c_f32_bf16 v103, v85, v113
v_dot2c_f32_bf16 v104, v86, v112
v_dot2c_f32_bf16 v105, v86, v113
v_dot2c_f32_bf16 v106, v87, v112
v_dot2c_f32_bf16 v107, v87, v113
v_dot2c_f32_bf16 v100, v88, v112
v_dot2c_f32_bf16 v101, v88, v113
v_dot2c_f32_bf16 v102, v89, v112
v_dot2c_f32_bf16 v103, v89, v113
v_dot2c_f32_bf16 v104, v90, v112
v_dot2c_f32_bf16 v105, v90, v113
v_dot2c_f32_bf16 v106, v91, v112
v_dot2c_f32_bf16 v107, v91, v113
v_dot2c_f32_bf16 v100, v92, v112
v_dot2c_f32_bf16 v101, v92, v113
v_dot2c_f32_bf16 v102, v93, v112
v_dot2c_f32_bf16 v103, v93, v113
v_dot2c_f32_bf16 v104, v94, v112
v_dot2c_f32_bf16 v105, v94, v113
v_dot2c_f32_bf16 v106, v95, v112
v_dot2c_f32_bf16 v107, v95, v113
s_nop 2
v_cvt_pk_bf16_f32 v124, v100, v101
v_cvt_pk_bf16_f32 v125, v102, v103
v_cvt_pk_bf16_f32 v126, v104, v105
v_cvt_pk_bf16_f32 v127, v106, v107
s_nop 0
v_permlane16_swap_b32 v124, v126
v_permlane16_swap_b32 v125, v127
ds_write_b128 v118, v[124:127] offset:8192
L_r2b:
s_waitcnt lgkmcnt(0)
s_barrier
ds_read_b128 v[0:3], v119 offset:0
ds_read_b128 v[4:7], v119 offset:4096
ds_read_b128 v[8:11], v119 offset:8192
s_waitcnt lgkmcnt(0)
s_add_u32 s48, s39, 0
s_and_b32 s51, s48, 1
s_lshl_b32 s51, s51, 5
s_lshl_b32 s57, s38, 6
s_add_u32 s51, s51, s57
s_mul_i32 s51, s51, 1152
s_lshr_b32 s56, s48, 1
s_lshl_b32 s56, s56, 7
s_add_u32 s51, s51, s56
buffer_store_dwordx4 v[0:3], v120, s[28:31], s51 offen
s_add_u32 s48, s39, 8
s_and_b32 s51, s48, 1
s_lshl_b32 s51, s51, 5
s_lshl_b32 s57, s38, 6
s_add_u32 s51, s51, s57
s_mul_i32 s51, s51, 1152
s_lshr_b32 s56, s48, 1
s_lshl_b32 s56, s56, 7
s_add_u32 s51, s51, s56
buffer_store_dwordx4 v[4:7], v120, s[28:31], s51 offen
s_cmp_ge_u32 s39, 2
s_cbranch_scc1 L_r2c
s_add_u32 s48, s39, 16
s_and_b32 s51, s48, 1
s_lshl_b32 s51, s51, 5
s_lshl_b32 s57, s38, 6
s_add_u32 s51, s51, s57
s_mul_i32 s51, s51, 1152
s_lshr_b32 s56, s48, 1
s_lshl_b32 s56, s56, 7
s_add_u32 s51, s51, s56
buffer_store_dwordx4 v[8:11], v120, s[28:31], s51 offen
L_r2c:
L_done:
s_endpgm
.section .rodata,"a"
.p2align 6
.amdhsa_kernel standalone__mha_block_cached__near_ridge_kernel
  .amdhsa_next_free_vgpr 512
  .amdhsa_next_free_sgpr 100
  .amdhsa_accum_offset 256
  .amdhsa_group_segment_fixed_size 0
  .amdhsa_kernarg_size 64
  .amdhsa_user_sgpr_count 2
  .amdhsa_user_sgpr_kernarg_segment_ptr 1
  .amdhsa_system_sgpr_workgroup_id_x 1
.end_amdhsa_kernel
```
